```python
import torch

def _softmax(x, axis=-1):
    return torch.softmax(x, dim=axis)
def _gelu(x):
    return torch.nn.functional.gelu(x, approximate="tanh")
def _silu(x):
    return torch.nn.functional.silu(x)
def _sigmoid(x):
    return torch.sigmoid(x)
def _layernorm(x, axis=-1, eps=1e-5):
    m = x.mean(dim=axis, keepdim=True)
    v = x.var(dim=axis, keepdim=True, unbiased=False)
    return (x - m) / torch.sqrt(v + eps)
def _scatter_add(tgt, idx, src, axis=0):
    return tgt.clone().index_add_(axis, idx, src)
def _segment_sum(src, seg, n):
    out = torch.zeros((n,) + src.shape[1:], dtype=src.dtype)
    return out.index_add_(0, seg, src)
def _pad(x, pw):
    flat = tuple(v for pair in reversed(pw) for v in pair)
    return torch.nn.functional.pad(x, flat)

kernel_name = 'gated_mix__grouped_kv_mqa__dense_activation_silu__prompt'

def setup_inputs():

    _w = (lambda a: (lambda t: t.to(torch.bfloat16) if t.is_floating_point() else t)(torch.as_tensor(a)))
    def _A_setup():
        B, S, D, H = 1, 2048, 512, 32
        Dh = D // H
        return {
            "x": _w((lambda *s: torch.randn(*s, dtype=torch.bfloat16) * 0.05)(B, S, D)),
            "wq": _w((lambda *s: torch.randn(*s, dtype=torch.bfloat16) * 0.8)(D, H * Dh)),
            "wk": _w((lambda *s: torch.randn(*s, dtype=torch.bfloat16) * 0.8)(D, Dh)),
            "wv": _w((lambda *s: torch.randn(*s, dtype=torch.bfloat16) * 0.05)(D, Dh)),
            "wo": _w((lambda *s: torch.randn(*s, dtype=torch.bfloat16) * 0.05)(H * Dh, D)),
        }
    _A_in = _A_setup()

    def _B_setup():
        B, S, D, F = 1, 2048, 512, 1376
        return {
            "x": _w((lambda *s: torch.randn(*s, dtype=torch.bfloat16) * 0.05)(B, S, D)),
            "w1": _w((lambda *s: torch.randn(*s, dtype=torch.bfloat16) * 3.2)(D, F) * (D ** -0.5)),
            "w2": _w((lambda *s: torch.randn(*s, dtype=torch.bfloat16) * 0.1)(F, D) * (F ** -0.5)),
        }
    _B_in = _B_setup()

    return {
        "A_x": _A_in["x"],
        "A_wq": _A_in["wq"],
        "A_wk": _A_in["wk"],
        "A_wv": _A_in["wv"],
        "A_wo": _A_in["wo"],
        "B_x": _B_in["x"],
        "B_w1": _B_in["w1"],
        "B_w2": _B_in["w2"],
        "gate_w": _w((lambda *s: torch.randn(*s, dtype=torch.bfloat16) * 0.05)(512) * 16.0),
    }

def reference(A_x, A_wq, A_wk, A_wv, A_wo, B_x, B_w1, B_w2, gate_w):
    def _A_ref(x, wq, wk, wv, wo):
        B, S, D = x.shape
        H = 32
        Dh = D // H
        q = (lambda x, *d: x.permute(*d))((x @ wq).reshape(B, S, H, Dh), 0, 2, 1, 3)
        k = x @ wk
        v = x @ wv
        scores = torch.einsum("bhqd,bkd->bhqk", q, k) * (Dh ** -0.5)
        p = _softmax(scores, axis=-1)
        o = torch.einsum("bhqk,bkd->bhqd", p, v)
        return (lambda x, *d: x.permute(*d))(o, 0, 2, 1, 3).reshape(B, S, H * Dh) @ wo

    def _B_ref(x, w1, w2):
        h = torch.einsum("bsd,df->bsf", x, w1)
        h = _silu(h)
        out = torch.einsum("bsf,fd->bsd", h, w2)
        return out

    x = A_x
    g = _sigmoid((x * gate_w).sum(-1, keepdims=True))
    a = _A_ref(x, A_wq, A_wk, A_wv, A_wo)
    b = _B_ref(x, B_w1, B_w2)
    return g * a + (1 - g) * b
```

```asm
; @launch grid=(256,1,1) block=(768,1,1) lds=163328
.amdgcn_target "amdgcn-amd-amdhsa--gfx950"
.text
.globl gated_mix__grouped_kv_mqa__dense_activation_silu__prompt_kernel
.p2align 8
.type gated_mix__grouped_kv_mqa__dense_activation_silu__prompt_kernel,@function
gated_mix__grouped_kv_mqa__dense_activation_silu__prompt_kernel:
    s_load_dwordx16 s[4:19], s[0:1], 0
    s_load_dwordx8 s[20:27], s[0:1], 64
    s_cmp_ge_u32 s2, 256
    s_cbranch_scc1 L_end
    v_lshrrev_b32 v5, 6, v0
    v_and_b32 v1, 63, v0
    v_readfirstlane_b32 s30, v5
    v_lshlrev_b32 v2, 4, v1
    s_bfe_u32 s50, s2, 0x20001
    s_bfe_u32 s32, s2, 0x30003
    s_lshl3_add_u32 s28, s50, s32
    s_and_b32 s50, s2, 1
    s_lshr_b32 s43, s2, 6
    s_lshl2_add_u32 s29, s50, s43
    s_lshl_b32 s32, s32, 1
    s_lshl_b32 s50, s43, 2
    s_xor_b32 s32, s32, s50
    s_and_b32 s32, s32, 6
    s_cmp_lt_u32 s30, 8
    s_cbranch_scc1 L_aw
    s_sub_u32 s31, s30, 8
    v_lshrrev_b32 v16, 4, v1
    v_and_b32 v17, 15, v1
    v_xor_b32 v17, v17, v16
    v_lshlrev_b32 v17, 4, v17
    v_lshl_add_u32 v20, v16, 10, v17
    v_xor_b32 v21, 4160, v20
    v_xor_b32 v22, 8320, v20
    v_xor_b32 v23, 12480, v20
    s_lshl2_add_u32 s52, s28, s31
    s_lshl_b32 s52, s52, 14
    s_lshl_b32 s33, s31, 12
    v_lshrrev_b32 v16, 5, v1
    v_bfe_u32 v19, v1, 2, 2
    v_lshl_add_u32 v16, v16, 2, v19
    s_lshl_b32 s54, s31, 3
    v_add_u32 v16, s54, v16
    v_bfe_u32 v17, v1, 4, 1
    v_and_b32 v18, 3, v1
    v_lshlrev_b32 v18, 4, v18
    v_lshl_add_u32 v24, v17, 6, v18
    v_lshl_add_u32 v24, v16, 10, v24
    s_waitcnt lgkmcnt(0)
    s_load_dword s58, s[26:27], 0x33000
    s_add_u32 s68, s4, s52
    s_addc_u32 s69, s5, 0
    s_xor_b32 s50, s32, 0
    s_lshr_b32 s50, s50, 2
    s_lshl_b32 s50, s50, 8
    s_add_u32 m0, s33, 66560
    s_add_u32 s66, s68, s50
    s_addc_u32 s67, s69, 0
    global_load_lds_dwordx4 v20, s[66:67]
    s_add_u32 m0, s33, 67584
    s_nop 0
    global_load_lds_dwordx4 v21, s[66:67]
    s_add_u32 m0, s33, 68608
    s_nop 0
    global_load_lds_dwordx4 v22, s[66:67]
    s_add_u32 m0, s33, 69632
    s_nop 0
    global_load_lds_dwordx4 v23, s[66:67]
    s_lshl_b32 s50, s29, 7
    s_add_u32 s6, s6, s50
    s_addc_u32 s7, s7, 0
    s_cmp_eq_u32 s29, 0
    s_cbranch_scc1 L_gprod
    s_mul_i32 s50, s29, 384
    s_sub_u32 s50, s50, 320
    s_add_u32 s16, s16, s50
    s_addc_u32 s17, s17, 0
    v_add_u32 v19, s54, v19
    v_mul_u32_u24 v25, 2752, v19
    v_lshrrev_b32 v26, 4, v1
    v_lshl_add_u32 v25, v26, 6, v25
    v_add_u32 v25, v25, v18
    v_add_u32 v26, 11008, v25
    v_mul_u32_u24 v27, 2752, v16
    v_lshl_add_u32 v27, v17, 6, v27
    v_add3_u32 v27, v27, v18, 64
    v_add_u32 v27, 192, v27
    s_xor_b32 s50, s32, 0
    s_lshl_b32 s52, s50, 15
    s_add_u32 m0, s33, 0
    s_add_u32 s34, s6, s52
    s_addc_u32 s35, s7, 0
    global_load_lds_dwordx4 v24, s[34:35]
    s_mul_i32 s52, s50, 88064
    s_add_u32 m0, s33, 3072
    s_add_u32 s64, s16, s52
    s_addc_u32 s65, s17, 0
    global_load_lds_dwordx4 v27, s[64:65]
    s_add_u32 m0, s33, 1024
    s_nop 0
    global_load_lds_dwordx4 v25, s[64:65]
    s_add_u32 m0, s33, 2048
    s_nop 0
    global_load_lds_dwordx4 v26, s[64:65]
    s_xor_b32 s50, s32, 1
    s_lshl_b32 s52, s50, 15
    s_add_u32 m0, s33, 16384
    s_add_u32 s34, s6, s52
    s_addc_u32 s35, s7, 0
    global_load_lds_dwordx4 v24, s[34:35]
    s_mul_i32 s52, s50, 88064
    s_add_u32 m0, s33, 19456
    s_add_u32 s64, s16, s52
    s_addc_u32 s65, s17, 0
    global_load_lds_dwordx4 v27, s[64:65]
    s_add_u32 m0, s33, 17408
    s_nop 0
    global_load_lds_dwordx4 v25, s[64:65]
    s_add_u32 m0, s33, 18432
    s_nop 0
    global_load_lds_dwordx4 v26, s[64:65]
    s_xor_b32 s50, s32, 2
    s_lshl_b32 s52, s50, 15
    s_add_u32 m0, s33, 32768
    s_add_u32 s34, s6, s52
    s_addc_u32 s35, s7, 0
    global_load_lds_dwordx4 v24, s[34:35]
    s_mul_i32 s52, s50, 88064
    s_add_u32 m0, s33, 35840
    s_add_u32 s64, s16, s52
    s_addc_u32 s65, s17, 0
    global_load_lds_dwordx4 v27, s[64:65]
    s_add_u32 m0, s33, 33792
    s_nop 0
    global_load_lds_dwordx4 v25, s[64:65]
    s_add_u32 m0, s33, 34816
    s_nop 0
    global_load_lds_dwordx4 v26, s[64:65]
    s_mov_b32 m0, 162304
    v_and_b32 v12, 15, v1
    global_load_lds_dwordx4 v2, s[20:21]
    v_lshlrev_b32 v12, 2, v12
    v_add_u32 v12, 162048, v12
    v_mov_b32 v13, 0
    ds_write_b32 v12, v13
    v_lshrrev_b32 v12, 2, v1
    v_and_b32 v13, 3, v1
    v_lshlrev_b32 v13, 2, v13
    v_xor_b32 v10, v13, v12
    v_lshlrev_b32 v10, 4, v10
    v_lshl_add_u32 v10, v12, 8, v10
    s_add_u32 s50, s33, 66560
    v_add_u32 v10, s50, v10
    s_lshr_b32 s50, s32, 2
    s_lshl_b32 s50, s50, 8
    v_lshl_add_u32 v11, v13, 4, s50
    v_mov_b32 v14, 0
    v_mov_b32 v15, 0
    v_and_b32 v30, 31, v1
    v_lshlrev_b32 v30, 7, v30
    v_add_u32 v30, 200704, v30
    s_add_u32 s44, s26, 0x0
    s_addc_u32 s45, s27, 0
    s_waitcnt lgkmcnt(0)
    s_add_u32 s58, s58, 0x9e3779b1
    s_waitcnt vmcnt(9)
    s_barrier
    s_xor_b32 s50, s32, 3
    s_lshl_b32 s52, s50, 15
    s_add_u32 m0, s33, 49152
    s_add_u32 s34, s6, s52
    s_addc_u32 s35, s7, 0
    global_load_lds_dwordx4 v24, s[34:35]
    s_mul_i32 s52, s50, 88064
    s_add_u32 m0, s33, 52224
    s_add_u32 s64, s16, s52
    s_addc_u32 s65, s17, 0
    global_load_lds_dwordx4 v27, s[64:65]
    s_add_u32 m0, s33, 50176
    s_nop 0
    global_load_lds_dwordx4 v25, s[64:65]
    s_add_u32 m0, s33, 51200
    s_nop 0
    global_load_lds_dwordx4 v26, s[64:65]
    s_waitcnt vmcnt(9)
    s_barrier
    s_xor_b32 s50, s32, 4
    s_lshr_b32 s50, s50, 2
    s_lshl_b32 s50, s50, 8
    s_add_u32 m0, s33, 82944
    s_add_u32 s66, s68, s50
    s_addc_u32 s67, s69, 0
    global_load_lds_dwordx4 v20, s[66:67]
    s_add_u32 m0, s33, 83968
    s_nop 0
    global_load_lds_dwordx4 v21, s[66:67]
    s_add_u32 m0, s33, 84992
    s_nop 0
    global_load_lds_dwordx4 v22, s[66:67]
    s_add_u32 m0, s33, 86016
    s_nop 0
    global_load_lds_dwordx4 v23, s[66:67]
    s_xor_b32 s50, s32, 4
    s_lshl_b32 s52, s50, 15
    s_add_u32 m0, s33, 0
    s_add_u32 s34, s6, s52
    s_addc_u32 s35, s7, 0
    global_load_lds_dwordx4 v24, s[34:35]
    s_mul_i32 s52, s50, 88064
    s_add_u32 m0, s33, 3072
    s_add_u32 s64, s16, s52
    s_addc_u32 s65, s17, 0
    global_load_lds_dwordx4 v27, s[64:65]
    s_add_u32 m0, s33, 1024
    s_nop 0
    global_load_lds_dwordx4 v25, s[64:65]
    s_add_u32 m0, s33, 2048
    s_nop 0
    global_load_lds_dwordx4 v26, s[64:65]
    s_waitcnt vmcnt(13)
    s_barrier
    s_xor_b32 s50, s32, 5
    s_lshl_b32 s52, s50, 15
    s_add_u32 m0, s33, 16384
    s_add_u32 s34, s6, s52
    s_addc_u32 s35, s7, 0
    global_load_lds_dwordx4 v24, s[34:35]
    s_mul_i32 s52, s50, 88064
    s_add_u32 m0, s33, 19456
    s_add_u32 s64, s16, s52
    s_addc_u32 s65, s17, 0
    global_load_lds_dwordx4 v27, s[64:65]
    s_add_u32 m0, s33, 17408
    s_nop 0
    global_load_lds_dwordx4 v25, s[64:65]
    s_add_u32 m0, s33, 18432
    s_nop 0
    global_load_lds_dwordx4 v26, s[64:65]
    s_waitcnt vmcnt(12)
    s_barrier
    s_xor_b32 s50, s32, 6
    s_lshl_b32 s52, s50, 15
    s_add_u32 m0, s33, 32768
    s_add_u32 s34, s6, s52
    s_addc_u32 s35, s7, 0
    global_load_lds_dwordx4 v24, s[34:35]
    s_mul_i32 s52, s50, 88064
    s_add_u32 m0, s33, 35840
    s_add_u32 s64, s16, s52
    s_addc_u32 s65, s17, 0
    global_load_lds_dwordx4 v27, s[64:65]
    s_add_u32 m0, s33, 33792
    s_nop 0
    global_load_lds_dwordx4 v25, s[64:65]
    s_add_u32 m0, s33, 34816
    s_nop 0
    global_load_lds_dwordx4 v26, s[64:65]
    s_waitcnt vmcnt(8)
    s_barrier
    s_xor_b32 s50, s32, 7
    s_lshl_b32 s52, s50, 15
    s_add_u32 m0, s33, 49152
    s_add_u32 s34, s6, s52
    s_addc_u32 s35, s7, 0
    global_load_lds_dwordx4 v24, s[34:35]
    s_mul_i32 s52, s50, 88064
    s_add_u32 m0, s33, 52224
    s_add_u32 s64, s16, s52
    s_addc_u32 s65, s17, 0
    global_load_lds_dwordx4 v27, s[64:65]
    s_add_u32 m0, s33, 50176
    s_nop 0
    global_load_lds_dwordx4 v25, s[64:65]
    s_add_u32 m0, s33, 51200
    s_nop 0
    global_load_lds_dwordx4 v26, s[64:65]
    v_xor_b32 v12, 0, v11
    v_add_u32 v12, 162304, v12
    ds_read_b128 v[32:35], v10 offset:0
    ds_read_b128 v[36:39], v12 offset:0
    v_xor_b32 v13, 16, v10
    ds_read_b128 v[40:43], v13 offset:0
    ds_read_b128 v[44:47], v12 offset:16
    v_xor_b32 v13, 32, v10
    ds_read_b128 v[48:51], v13 offset:0
    ds_read_b128 v[52:55], v12 offset:32
    v_xor_b32 v13, 48, v10
    ds_read_b128 v[56:59], v13 offset:0
    ds_read_b128 v[60:63], v12 offset:48
    s_waitcnt lgkmcnt(6)
    v_dot2_f32_bf16 v14, v32, v36, v14
    v_dot2_f32_bf16 v15, v33, v37, v15
    v_dot2_f32_bf16 v14, v34, v38, v14
    v_dot2_f32_bf16 v15, v35, v39, v15
    s_waitcnt lgkmcnt(4)
    v_dot2_f32_bf16 v14, v40, v44, v14
    v_dot2_f32_bf16 v15, v41, v45, v15
    v_dot2_f32_bf16 v14, v42, v46, v14
    v_dot2_f32_bf16 v15, v43, v47, v15
    s_waitcnt lgkmcnt(2)
    v_dot2_f32_bf16 v14, v48, v52, v14
    v_dot2_f32_bf16 v15, v49, v53, v15
    v_dot2_f32_bf16 v14, v50, v54, v14
    v_dot2_f32_bf16 v15, v51, v55, v15
    s_waitcnt lgkmcnt(0)
    v_dot2_f32_bf16 v14, v56, v60, v14
    v_dot2_f32_bf16 v15, v57, v61, v15
    v_dot2_f32_bf16 v14, v58, v62, v14
    v_dot2_f32_bf16 v15, v59, v63, v15
    s_waitcnt vmcnt(8)
    s_barrier
    s_xor_b32 s50, s32, 8
    s_lshr_b32 s50, s50, 2
    s_lshl_b32 s50, s50, 8
    s_add_u32 m0, s33, 99328
    s_add_u32 s66, s68, s50
    s_addc_u32 s67, s69, 0
    global_load_lds_dwordx4 v20, s[66:67]
    s_add_u32 m0, s33, 100352
    s_nop 0
    global_load_lds_dwordx4 v21, s[66:67]
    s_add_u32 m0, s33, 101376
    s_nop 0
    global_load_lds_dwordx4 v22, s[66:67]
    s_add_u32 m0, s33, 102400
    s_nop 0
    global_load_lds_dwordx4 v23, s[66:67]
    s_xor_b32 s50, s32, 8
    s_lshl_b32 s52, s50, 15
    s_add_u32 m0, s33, 0
    s_add_u32 s34, s6, s52
    s_addc_u32 s35, s7, 0
    global_load_lds_dwordx4 v24, s[34:35]
    s_mul_i32 s52, s50, 88064
    s_add_u32 m0, s33, 3072
    s_add_u32 s64, s16, s52
    s_addc_u32 s65, s17, 0
    global_load_lds_dwordx4 v27, s[64:65]
    s_add_u32 m0, s33, 1024
    s_nop 0
    global_load_lds_dwordx4 v25, s[64:65]
    s_add_u32 m0, s33, 2048
    s_nop 0
    global_load_lds_dwordx4 v26, s[64:65]
    s_waitcnt vmcnt(12)
    s_barrier
    s_xor_b32 s50, s32, 9
    s_lshl_b32 s52, s50, 15
    s_add_u32 m0, s33, 16384
    s_add_u32 s34, s6, s52
    s_addc_u32 s35, s7, 0
    global_load_lds_dwordx4 v24, s[34:35]
    s_mul_i32 s52, s50, 88064
    s_add_u32 m0, s33, 19456
    s_add_u32 s64, s16, s52
    s_addc_u32 s65, s17, 0
    global_load_lds_dwordx4 v27, s[64:65]
    s_add_u32 m0, s33, 17408
    s_nop 0
    global_load_lds_dwordx4 v25, s[64:65]
    s_add_u32 m0, s33, 18432
    s_nop 0
    global_load_lds_dwordx4 v26, s[64:65]
    v_xor_b32 v12, 256, v11
    v_add_u32 v12, 162304, v12
    ds_read_b128 v[32:35], v10 offset:16384
    ds_read_b128 v[36:39], v12 offset:0
    v_xor_b32 v13, 16, v10
    ds_read_b128 v[40:43], v13 offset:16384
    ds_read_b128 v[44:47], v12 offset:16
    v_xor_b32 v13, 32, v10
    ds_read_b128 v[48:51], v13 offset:16384
    ds_read_b128 v[52:55], v12 offset:32
    v_xor_b32 v13, 48, v10
    ds_read_b128 v[56:59], v13 offset:16384
    ds_read_b128 v[60:63], v12 offset:48
    s_waitcnt lgkmcnt(6)
    v_dot2_f32_bf16 v14, v32, v36, v14
    v_dot2_f32_bf16 v15, v33, v37, v15
    v_dot2_f32_bf16 v14, v34, v38, v14
    v_dot2_f32_bf16 v15, v35, v39, v15
    s_waitcnt lgkmcnt(4)
    v_dot2_f32_bf16 v14, v40, v44, v14
    v_dot2_f32_bf16 v15, v41, v45, v15
    v_dot2_f32_bf16 v14, v42, v46, v14
    v_dot2_f32_bf16 v15, v43, v47, v15
    s_waitcnt lgkmcnt(2)
    v_dot2_f32_bf16 v14, v48, v52, v14
    v_dot2_f32_bf16 v15, v49, v53, v15
    v_dot2_f32_bf16 v14, v50, v54, v14
    v_dot2_f32_bf16 v15, v51, v55, v15
    s_waitcnt lgkmcnt(0)
    v_dot2_f32_bf16 v14, v56, v60, v14
    v_dot2_f32_bf16 v15, v57, v61, v15
    v_dot2_f32_bf16 v14, v58, v62, v14
    v_dot2_f32_bf16 v15, v59, v63, v15
    s_waitcnt vmcnt(12)
    s_barrier
    s_xor_b32 s50, s32, 10
    s_lshl_b32 s52, s50, 15
    s_add_u32 m0, s33, 32768
    s_add_u32 s34, s6, s52
    s_addc_u32 s35, s7, 0
    global_load_lds_dwordx4 v24, s[34:35]
    s_mul_i32 s52, s50, 88064
    s_add_u32 m0, s33, 35840
    s_add_u32 s64, s16, s52
    s_addc_u32 s65, s17, 0
    global_load_lds_dwordx4 v27, s[64:65]
    s_add_u32 m0, s33, 33792
    s_nop 0
    global_load_lds_dwordx4 v25, s[64:65]
    s_add_u32 m0, s33, 34816
    s_nop 0
    global_load_lds_dwordx4 v26, s[64:65]
    s_waitcnt vmcnt(8)
    s_barrier
    s_xor_b32 s50, s32, 11
    s_lshl_b32 s52, s50, 15
    s_add_u32 m0, s33, 49152
    s_add_u32 s34, s6, s52
    s_addc_u32 s35, s7, 0
    global_load_lds_dwordx4 v24, s[34:35]
    s_mul_i32 s52, s50, 88064
    s_add_u32 m0, s33, 52224
    s_add_u32 s64, s16, s52
    s_addc_u32 s65, s17, 0
    global_load_lds_dwordx4 v27, s[64:65]
    s_add_u32 m0, s33, 50176
    s_nop 0
    global_load_lds_dwordx4 v25, s[64:65]
    s_add_u32 m0, s33, 51200
    s_nop 0
    global_load_lds_dwordx4 v26, s[64:65]
    s_waitcnt vmcnt(8)
    s_barrier
    s_xor_b32 s50, s32, 12
    s_lshr_b32 s50, s50, 2
    s_lshl_b32 s50, s50, 8
    s_add_u32 m0, s33, 115712
    s_add_u32 s66, s68, s50
    s_addc_u32 s67, s69, 0
    global_load_lds_dwordx4 v20, s[66:67]
    s_add_u32 m0, s33, 116736
    s_nop 0
    global_load_lds_dwordx4 v21, s[66:67]
    s_add_u32 m0, s33, 117760
    s_nop 0
    global_load_lds_dwordx4 v22, s[66:67]
    s_add_u32 m0, s33, 118784
    s_nop 0
    global_load_lds_dwordx4 v23, s[66:67]
    s_xor_b32 s50, s32, 12
    s_lshl_b32 s52, s50, 15
    s_add_u32 m0, s33, 0
    s_add_u32 s34, s6, s52
    s_addc_u32 s35, s7, 0
    global_load_lds_dwordx4 v24, s[34:35]
    s_mul_i32 s52, s50, 88064
    s_add_u32 m0, s33, 3072
    s_add_u32 s64, s16, s52
    s_addc_u32 s65, s17, 0
    global_load_lds_dwordx4 v27, s[64:65]
    s_add_u32 m0, s33, 1024
    s_nop 0
    global_load_lds_dwordx4 v25, s[64:65]
    s_add_u32 m0, s33, 2048
    s_nop 0
    global_load_lds_dwordx4 v26, s[64:65]
    v_xor_b32 v12, 512, v11
    v_add_u32 v12, 162304, v12
    ds_read_b128 v[32:35], v10 offset:32768
    ds_read_b128 v[36:39], v12 offset:0
    v_xor_b32 v13, 16, v10
    ds_read_b128 v[40:43], v13 offset:32768
    ds_read_b128 v[44:47], v12 offset:16
    v_xor_b32 v13, 32, v10
    ds_read_b128 v[48:51], v13 offset:32768
    ds_read_b128 v[52:55], v12 offset:32
    v_xor_b32 v13, 48, v10
    ds_read_b128 v[56:59], v13 offset:32768
    ds_read_b128 v[60:63], v12 offset:48
    s_waitcnt lgkmcnt(6)
    v_dot2_f32_bf16 v14, v32, v36, v14
    v_dot2_f32_bf16 v15, v33, v37, v15
    v_dot2_f32_bf16 v14, v34, v38, v14
    v_dot2_f32_bf16 v15, v35, v39, v15
    s_waitcnt lgkmcnt(4)
    v_dot2_f32_bf16 v14, v40, v44, v14
    v_dot2_f32_bf16 v15, v41, v45, v15
    v_dot2_f32_bf16 v14, v42, v46, v14
    v_dot2_f32_bf16 v15, v43, v47, v15
    s_waitcnt lgkmcnt(2)
    v_dot2_f32_bf16 v14, v48, v52, v14
    v_dot2_f32_bf16 v15, v49, v53, v15
    v_dot2_f32_bf16 v14, v50, v54, v14
    v_dot2_f32_bf16 v15, v51, v55, v15
    s_waitcnt lgkmcnt(0)
    v_dot2_f32_bf16 v14, v56, v60, v14
    v_dot2_f32_bf16 v15, v57, v61, v15
    v_dot2_f32_bf16 v14, v58, v62, v14
    v_dot2_f32_bf16 v15, v59, v63, v15
    s_waitcnt vmcnt(12)
    s_barrier
    global_load_dword v31, v30, s[26:27] sc1
    s_xor_b32 s50, s32, 13
    s_lshl_b32 s52, s50, 15
    s_add_u32 m0, s33, 16384
    s_add_u32 s34, s6, s52
    s_addc_u32 s35, s7, 0
    global_load_lds_dwordx4 v24, s[34:35]
    s_mul_i32 s52, s50, 88064
    s_add_u32 m0, s33, 19456
    s_add_u32 s64, s16, s52
    s_addc_u32 s65, s17, 0
    global_load_lds_dwordx4 v27, s[64:65]
    s_add_u32 m0, s33, 17408
    s_nop 0
    global_load_lds_dwordx4 v25, s[64:65]
    s_add_u32 m0, s33, 18432
    s_nop 0
    global_load_lds_dwordx4 v26, s[64:65]
    s_waitcnt vmcnt(13)
    s_barrier
    s_xor_b32 s50, s32, 14
    s_lshl_b32 s52, s50, 15
    s_add_u32 m0, s33, 32768
    s_add_u32 s34, s6, s52
    s_addc_u32 s35, s7, 0
    global_load_lds_dwordx4 v24, s[34:35]
    s_mul_i32 s52, s50, 88064
    s_add_u32 m0, s33, 35840
    s_add_u32 s64, s16, s52
    s_addc_u32 s65, s17, 0
    global_load_lds_dwordx4 v27, s[64:65]
    s_add_u32 m0, s33, 33792
    s_nop 0
    global_load_lds_dwordx4 v25, s[64:65]
    s_add_u32 m0, s33, 34816
    s_nop 0
    global_load_lds_dwordx4 v26, s[64:65]
    s_waitcnt vmcnt(9)
    s_barrier
    s_xor_b32 s50, s32, 15
    s_lshl_b32 s52, s50, 15
    s_add_u32 m0, s33, 49152
    s_add_u32 s34, s6, s52
    s_addc_u32 s35, s7, 0
    global_load_lds_dwordx4 v24, s[34:35]
    s_mul_i32 s52, s50, 88064
    s_add_u32 m0, s33, 52224
    s_add_u32 s64, s16, s52
    s_addc_u32 s65, s17, 0
    global_load_lds_dwordx4 v27, s[64:65]
    s_add_u32 m0, s33, 50176
    s_nop 0
    global_load_lds_dwordx4 v25, s[64:65]
    s_add_u32 m0, s33, 51200
    s_nop 0
    global_load_lds_dwordx4 v26, s[64:65]
    s_waitcnt vmcnt(8)
    s_barrier
    v_cmp_ne_u32 vcc, s58, v31
    s_mov_b32 s41, 0
    s_cbranch_vccnz L_slown
    s_mov_b32 s41, 1
    s_add_u32 s50, s33, 0
    s_mov_b32 m0, s50
    s_add_u32 s66, s44, s50
    s_addc_u32 s67, s45, 0
    global_load_lds_dwordx4 v2, s[66:67] offset:0 sc1
    global_load_lds_dwordx4 v2, s[66:67] offset:1024 sc1
    global_load_lds_dwordx4 v2, s[66:67] offset:2048 sc1
    global_load_lds_dwordx4 v2, s[66:67] offset:3072 sc1
    v_xor_b32 v12, 768, v11
    v_add_u32 v12, 162304, v12
    ds_read_b128 v[32:35], v10 offset:49152
    ds_read_b128 v[36:39], v12 offset:0
    v_xor_b32 v13, 16, v10
    ds_read_b128 v[40:43], v13 offset:49152
    ds_read_b128 v[44:47], v12 offset:16
    v_xor_b32 v13, 32, v10
    ds_read_b128 v[48:51], v13 offset:49152
    ds_read_b128 v[52:55], v12 offset:32
    v_xor_b32 v13, 48, v10
    ds_read_b128 v[56:59], v13 offset:49152
    ds_read_b128 v[60:63], v12 offset:48
    s_waitcnt lgkmcnt(6)
    v_dot2_f32_bf16 v14, v32, v36, v14
    v_dot2_f32_bf16 v15, v33, v37, v15
    v_dot2_f32_bf16 v14, v34, v38, v14
    v_dot2_f32_bf16 v15, v35, v39, v15
    s_waitcnt lgkmcnt(4)
    v_dot2_f32_bf16 v14, v40, v44, v14
    v_dot2_f32_bf16 v15, v41, v45, v15
    v_dot2_f32_bf16 v14, v42, v46, v14
    v_dot2_f32_bf16 v15, v43, v47, v15
    s_waitcnt lgkmcnt(2)
    v_dot2_f32_bf16 v14, v48, v52, v14
    v_dot2_f32_bf16 v15, v49, v53, v15
    v_dot2_f32_bf16 v14, v50, v54, v14
    v_dot2_f32_bf16 v15, v51, v55, v15
    s_waitcnt lgkmcnt(0)
    v_dot2_f32_bf16 v14, v56, v60, v14
    v_dot2_f32_bf16 v15, v57, v61, v15
    v_dot2_f32_bf16 v14, v58, v62, v14
    v_dot2_f32_bf16 v15, v59, v63, v15
    s_waitcnt vmcnt(8)
    s_barrier
    s_add_u32 s50, s33, 16384
    s_mov_b32 m0, s50
    s_add_u32 s66, s44, s50
    s_addc_u32 s67, s45, 0
    global_load_lds_dwordx4 v2, s[66:67] offset:0 sc1
    global_load_lds_dwordx4 v2, s[66:67] offset:1024 sc1
    global_load_lds_dwordx4 v2, s[66:67] offset:2048 sc1
    global_load_lds_dwordx4 v2, s[66:67] offset:3072 sc1
    s_waitcnt vmcnt(8)
    s_barrier
    s_add_u32 s50, s33, 32768
    s_mov_b32 m0, s50
    s_add_u32 s66, s44, s50
    s_addc_u32 s67, s45, 0
    global_load_lds_dwordx4 v2, s[66:67] offset:0 sc1
    global_load_lds_dwordx4 v2, s[66:67] offset:1024 sc1
    global_load_lds_dwordx4 v2, s[66:67] offset:2048 sc1
    global_load_lds_dwordx4 v2, s[66:67] offset:3072 sc1
    s_branch L_g4
L_slown:
    global_load_dword v31, v30, s[26:27] sc1
    v_xor_b32 v12, 768, v11
    v_add_u32 v12, 162304, v12
    ds_read_b128 v[32:35], v10 offset:49152
    ds_read_b128 v[36:39], v12 offset:0
    v_xor_b32 v13, 16, v10
    ds_read_b128 v[40:43], v13 offset:49152
    ds_read_b128 v[44:47], v12 offset:16
    v_xor_b32 v13, 32, v10
    ds_read_b128 v[48:51], v13 offset:49152
    ds_read_b128 v[52:55], v12 offset:32
    v_xor_b32 v13, 48, v10
    ds_read_b128 v[56:59], v13 offset:49152
    ds_read_b128 v[60:63], v12 offset:48
    s_waitcnt lgkmcnt(6)
    v_dot2_f32_bf16 v14, v32, v36, v14
    v_dot2_f32_bf16 v15, v33, v37, v15
    v_dot2_f32_bf16 v14, v34, v38, v14
    v_dot2_f32_bf16 v15, v35, v39, v15
    s_waitcnt lgkmcnt(4)
    v_dot2_f32_bf16 v14, v40, v44, v14
    v_dot2_f32_bf16 v15, v41, v45, v15
    v_dot2_f32_bf16 v14, v42, v46, v14
    v_dot2_f32_bf16 v15, v43, v47, v15
    s_waitcnt lgkmcnt(2)
    v_dot2_f32_bf16 v14, v48, v52, v14
    v_dot2_f32_bf16 v15, v49, v53, v15
    v_dot2_f32_bf16 v14, v50, v54, v14
    v_dot2_f32_bf16 v15, v51, v55, v15
    s_waitcnt lgkmcnt(0)
    v_dot2_f32_bf16 v14, v56, v60, v14
    v_dot2_f32_bf16 v15, v57, v61, v15
    v_dot2_f32_bf16 v14, v58, v62, v14
    v_dot2_f32_bf16 v15, v59, v63, v15
    s_waitcnt vmcnt(5)
    s_barrier
    s_waitcnt vmcnt(0)
    s_barrier
    v_cmp_ne_u32 vcc, s58, v31
    s_cbranch_vccnz L_g4
    s_mov_b32 s41, 1
    s_add_u32 s50, s33, 0
    s_mov_b32 m0, s50
    s_add_u32 s66, s44, s50
    s_addc_u32 s67, s45, 0
    global_load_lds_dwordx4 v2, s[66:67] offset:0 sc1
    global_load_lds_dwordx4 v2, s[66:67] offset:1024 sc1
    global_load_lds_dwordx4 v2, s[66:67] offset:2048 sc1
    global_load_lds_dwordx4 v2, s[66:67] offset:3072 sc1
    s_add_u32 s50, s33, 16384
    s_mov_b32 m0, s50
    s_add_u32 s66, s44, s50
    s_addc_u32 s67, s45, 0
    global_load_lds_dwordx4 v2, s[66:67] offset:0 sc1
    global_load_lds_dwordx4 v2, s[66:67] offset:1024 sc1
    global_load_lds_dwordx4 v2, s[66:67] offset:2048 sc1
    global_load_lds_dwordx4 v2, s[66:67] offset:3072 sc1
    s_add_u32 s50, s33, 32768
    s_mov_b32 m0, s50
    s_add_u32 s66, s44, s50
    s_addc_u32 s67, s45, 0
    global_load_lds_dwordx4 v2, s[66:67] offset:0 sc1
    global_load_lds_dwordx4 v2, s[66:67] offset:1024 sc1
    global_load_lds_dwordx4 v2, s[66:67] offset:2048 sc1
    global_load_lds_dwordx4 v2, s[66:67] offset:3072 sc1
    s_branch L_g4
L_gprod:
    v_lshrrev_b32 v28, 2, v1
    v_lshlrev_b32 v28, 5, v28
    v_and_b32 v19, 16, v18
    v_add3_u32 v28, v28, v19, s33
    v_mov_b32 v29, 0
    v_and_b32 v19, 2, v1
    v_cmp_ne_u32 vcc, 0, v19
    v_mov_b32 v32, s8
    v_mov_b32 v33, s9
    v_mov_b32 v34, s10
    v_mov_b32 v35, s11
    v_cndmask_b32 v32, v32, v34, vcc
    v_cndmask_b32 v33, v33, v35, vcc
    v_lshl_add_u64 v[32:33], v[28:29], 0, v[32:33]
    s_lshl_b32 s54, s33, 1
    s_and_b32 s56, s28, 7
    s_mov_b32 s65, 0
    s_xor_b32 s50, s56, 0
    s_lshl_b32 s64, s50, 9
    s_lshl_b32 s50, s50, 10
    s_add_u32 s50, s50, s54
    s_add_u32 m0, s50, 32768
    v_lshl_add_u64 v[28:29], v[32:33], 0, s[64:65]
    global_load_lds_dwordx4 v[28:29], off
    s_xor_b32 s50, s32, 4
    s_lshr_b32 s50, s50, 2
    s_lshl_b32 s50, s50, 8
    s_add_u32 m0, s33, 82944
    s_add_u32 s66, s68, s50
    s_addc_u32 s67, s69, 0
    global_load_lds_dwordx4 v20, s[66:67]
    s_add_u32 m0, s33, 83968
    s_nop 0
    global_load_lds_dwordx4 v21, s[66:67]
    s_add_u32 m0, s33, 84992
    s_nop 0
    global_load_lds_dwordx4 v22, s[66:67]
    s_add_u32 m0, s33, 86016
    s_nop 0
    global_load_lds_dwordx4 v23, s[66:67]
    s_xor_b32 s50, s32, 8
    s_lshr_b32 s50, s50, 2
    s_lshl_b32 s50, s50, 8
    s_add_u32 m0, s33, 99328
    s_add_u32 s66, s68, s50
    s_addc_u32 s67, s69, 0
    global_load_lds_dwordx4 v20, s[66:67]
    s_add_u32 m0, s33, 100352
    s_nop 0
    global_load_lds_dwordx4 v21, s[66:67]
    s_add_u32 m0, s33, 101376
    s_nop 0
    global_load_lds_dwordx4 v22, s[66:67]
    s_add_u32 m0, s33, 102400
    s_nop 0
    global_load_lds_dwordx4 v23, s[66:67]
    s_xor_b32 s50, s32, 12
    s_lshr_b32 s50, s50, 2
    s_lshl_b32 s50, s50, 8
    s_add_u32 m0, s33, 115712
    s_add_u32 s66, s68, s50
    s_addc_u32 s67, s69, 0
    global_load_lds_dwordx4 v20, s[66:67]
    s_add_u32 m0, s33, 116736
    s_nop 0
    global_load_lds_dwordx4 v21, s[66:67]
    s_add_u32 m0, s33, 117760
    s_nop 0
    global_load_lds_dwordx4 v22, s[66:67]
    s_add_u32 m0, s33, 118784
    s_nop 0
    global_load_lds_dwordx4 v23, s[66:67]
    s_xor_b32 s50, s56, 1
    s_lshl_b32 s64, s50, 9
    s_lshl_b32 s50, s50, 10
    s_add_u32 s50, s50, s54
    s_add_u32 m0, s50, 32768
    v_lshl_add_u64 v[28:29], v[32:33], 0, s[64:65]
    global_load_lds_dwordx4 v[28:29], off
    s_xor_b32 s50, s56, 2
    s_lshl_b32 s64, s50, 9
    s_lshl_b32 s50, s50, 10
    s_add_u32 s50, s50, s54
    s_add_u32 m0, s50, 32768
    v_lshl_add_u64 v[28:29], v[32:33], 0, s[64:65]
    global_load_lds_dwordx4 v[28:29], off
    s_xor_b32 s50, s56, 3
    s_lshl_b32 s64, s50, 9
    s_lshl_b32 s50, s50, 10
    s_add_u32 s50, s50, s54
    s_add_u32 m0, s50, 32768
    v_lshl_add_u64 v[28:29], v[32:33], 0, s[64:65]
    global_load_lds_dwordx4 v[28:29], off
    s_xor_b32 s50, s56, 4
    s_lshl_b32 s64, s50, 9
    s_lshl_b32 s50, s50, 10
    s_add_u32 s50, s50, s54
    s_add_u32 m0, s50, 32768
    v_lshl_add_u64 v[28:29], v[32:33], 0, s[64:65]
    global_load_lds_dwordx4 v[28:29], off
    s_xor_b32 s50, s56, 5
    s_lshl_b32 s64, s50, 9
    s_lshl_b32 s50, s50, 10
    s_add_u32 s50, s50, s54
    s_add_u32 m0, s50, 32768
    v_lshl_add_u64 v[28:29], v[32:33], 0, s[64:65]
    global_load_lds_dwordx4 v[28:29], off
    s_xor_b32 s50, s56, 6
    s_lshl_b32 s64, s50, 9
    s_lshl_b32 s50, s50, 10
    s_add_u32 s50, s50, s54
    s_add_u32 m0, s50, 32768
    v_lshl_add_u64 v[28:29], v[32:33], 0, s[64:65]
    global_load_lds_dwordx4 v[28:29], off
    s_xor_b32 s50, s56, 7
    s_lshl_b32 s64, s50, 9
    s_lshl_b32 s50, s50, 10
    s_add_u32 s50, s50, s54
    s_add_u32 m0, s50, 32768
    v_lshl_add_u64 v[28:29], v[32:33], 0, s[64:65]
    global_load_lds_dwordx4 v[28:29], off
    v_mul_u32_u24 v27, 2752, v16
    v_add_u32 v27, v27, v18
    s_mov_b32 m0, 162304
    v_and_b32 v12, 15, v1
    global_load_lds_dwordx4 v2, s[20:21]
    v_lshlrev_b32 v12, 2, v12
    v_add_u32 v12, 162048, v12
    v_mov_b32 v13, 0
    ds_write_b32 v12, v13
    v_lshrrev_b32 v12, 2, v1
    v_and_b32 v13, 3, v1
    v_lshlrev_b32 v13, 2, v13
    v_xor_b32 v10, v13, v12
    v_lshlrev_b32 v10, 4, v10
    v_lshl_add_u32 v10, v12, 8, v10
    s_add_u32 s50, s33, 66560
    v_add_u32 v10, s50, v10
    s_lshr_b32 s50, s32, 2
    s_lshl_b32 s50, s50, 8
    v_lshl_add_u32 v11, v13, 4, s50
    v_mov_b32 v14, 0
    v_mov_b32 v15, 0
    v_and_b32 v30, 31, v1
    v_lshlrev_b32 v30, 7, v30
    v_add_u32 v30, 200704, v30
    s_add_u32 s44, s26, 0x0
    s_addc_u32 s45, s27, 0
    s_waitcnt lgkmcnt(0)
    s_add_u32 s58, s58, 0x9e3779b1
    s_waitcnt vmcnt(4)
    s_xor_b32 s50, s32, 0
    s_lshl_b32 s52, s50, 15
    s_add_u32 m0, s33, 0
    s_add_u32 s34, s6, s52
    s_addc_u32 s35, s7, 0
    global_load_lds_dwordx4 v24, s[34:35]
    s_mul_i32 s52, s50, 88064
    s_add_u32 m0, s33, 3072
    s_add_u32 s64, s16, s52
    s_addc_u32 s65, s17, 0
    global_load_lds_dwordx4 v27, s[64:65]
    s_xor_b32 s50, s32, 1
    s_lshl_b32 s52, s50, 15
    s_add_u32 m0, s33, 16384
    s_add_u32 s34, s6, s52
    s_addc_u32 s35, s7, 0
    global_load_lds_dwordx4 v24, s[34:35]
    s_mul_i32 s52, s50, 88064
    s_add_u32 m0, s33, 19456
    s_add_u32 s64, s16, s52
    s_addc_u32 s65, s17, 0
    global_load_lds_dwordx4 v27, s[64:65]
    s_waitcnt vmcnt(4)
    s_barrier
    s_barrier
    s_xor_b32 s50, s32, 2
    s_lshl_b32 s52, s50, 15
    s_add_u32 m0, s33, 32768
    s_add_u32 s34, s6, s52
    s_addc_u32 s35, s7, 0
    global_load_lds_dwordx4 v24, s[34:35]
    s_mul_i32 s52, s50, 88064
    s_add_u32 m0, s33, 35840
    s_add_u32 s64, s16, s52
    s_addc_u32 s65, s17, 0
    global_load_lds_dwordx4 v27, s[64:65]
    s_waitcnt vmcnt(4)
    s_barrier
    s_xor_b32 s50, s32, 3
    s_lshl_b32 s52, s50, 15
    s_add_u32 m0, s33, 49152
    s_add_u32 s34, s6, s52
    s_addc_u32 s35, s7, 0
    global_load_lds_dwordx4 v24, s[34:35]
    s_mul_i32 s52, s50, 88064
    s_add_u32 m0, s33, 52224
    s_add_u32 s64, s16, s52
    s_addc_u32 s65, s17, 0
    global_load_lds_dwordx4 v27, s[64:65]
    s_waitcnt vmcnt(4)
    s_barrier
    s_xor_b32 s50, s32, 4
    s_lshl_b32 s52, s50, 15
    s_add_u32 m0, s33, 0
    s_add_u32 s34, s6, s52
    s_addc_u32 s35, s7, 0
    global_load_lds_dwordx4 v24, s[34:35]
    s_mul_i32 s52, s50, 88064
    s_add_u32 m0, s33, 3072
    s_add_u32 s64, s16, s52
    s_addc_u32 s65, s17, 0
    global_load_lds_dwordx4 v27, s[64:65]
    s_waitcnt vmcnt(4)
    s_barrier
    s_xor_b32 s50, s32, 5
    s_lshl_b32 s52, s50, 15
    s_add_u32 m0, s33, 16384
    s_add_u32 s34, s6, s52
    s_addc_u32 s35, s7, 0
    global_load_lds_dwordx4 v24, s[34:35]
    s_mul_i32 s52, s50, 88064
    s_add_u32 m0, s33, 19456
    s_add_u32 s64, s16, s52
    s_addc_u32 s65, s17, 0
    global_load_lds_dwordx4 v27, s[64:65]
    s_waitcnt vmcnt(4)
    s_barrier
    s_xor_b32 s50, s32, 6
    s_lshl_b32 s52, s50, 15
    s_add_u32 m0, s33, 32768
    s_add_u32 s34, s6, s52
    s_addc_u32 s35, s7, 0
    global_load_lds_dwordx4 v24, s[34:35]
    s_mul_i32 s52, s50, 88064
    s_add_u32 m0, s33, 35840
    s_add_u32 s64, s16, s52
    s_addc_u32 s65, s17, 0
    global_load_lds_dwordx4 v27, s[64:65]
    s_waitcnt vmcnt(4)
    s_barrier
    s_xor_b32 s50, s32, 7
    s_lshl_b32 s52, s50, 15
    s_add_u32 m0, s33, 49152
    s_add_u32 s34, s6, s52
    s_addc_u32 s35, s7, 0
    global_load_lds_dwordx4 v24, s[34:35]
    s_mul_i32 s52, s50, 88064
    s_add_u32 m0, s33, 52224
    s_add_u32 s64, s16, s52
    s_addc_u32 s65, s17, 0
    global_load_lds_dwordx4 v27, s[64:65]
    v_xor_b32 v12, 0, v11
    v_add_u32 v12, 162304, v12
    ds_read_b128 v[32:35], v10 offset:0
    ds_read_b128 v[36:39], v12 offset:0
    v_xor_b32 v13, 16, v10
    ds_read_b128 v[40:43], v13 offset:0
    ds_read_b128 v[44:47], v12 offset:16
    v_xor_b32 v13, 32, v10
    ds_read_b128 v[48:51], v13 offset:0
    ds_read_b128 v[52:55], v12 offset:32
    v_xor_b32 v13, 48, v10
    ds_read_b128 v[56:59], v13 offset:0
    ds_read_b128 v[60:63], v12 offset:48
    s_waitcnt lgkmcnt(6)
    v_dot2_f32_bf16 v14, v32, v36, v14
    v_dot2_f32_bf16 v15, v33, v37, v15
    v_dot2_f32_bf16 v14, v34, v38, v14
    v_dot2_f32_bf16 v15, v35, v39, v15
    s_waitcnt lgkmcnt(4)
    v_dot2_f32_bf16 v14, v40, v44, v14
    v_dot2_f32_bf16 v15, v41, v45, v15
    v_dot2_f32_bf16 v14, v42, v46, v14
    v_dot2_f32_bf16 v15, v43, v47, v15
    s_waitcnt lgkmcnt(2)
    v_dot2_f32_bf16 v14, v48, v52, v14
    v_dot2_f32_bf16 v15, v49, v53, v15
    v_dot2_f32_bf16 v14, v50, v54, v14
    v_dot2_f32_bf16 v15, v51, v55, v15
    s_waitcnt lgkmcnt(0)
    v_dot2_f32_bf16 v14, v56, v60, v14
    v_dot2_f32_bf16 v15, v57, v61, v15
    v_dot2_f32_bf16 v14, v58, v62, v14
    v_dot2_f32_bf16 v15, v59, v63, v15
    s_waitcnt vmcnt(4)
    s_barrier
    s_xor_b32 s50, s32, 8
    s_lshl_b32 s52, s50, 15
    s_add_u32 m0, s33, 0
    s_add_u32 s34, s6, s52
    s_addc_u32 s35, s7, 0
    global_load_lds_dwordx4 v24, s[34:35]
    s_mul_i32 s52, s50, 88064
    s_add_u32 m0, s33, 3072
    s_add_u32 s64, s16, s52
    s_addc_u32 s65, s17, 0
    global_load_lds_dwordx4 v27, s[64:65]
    s_waitcnt vmcnt(4)
    s_barrier
    s_xor_b32 s50, s32, 9
    s_lshl_b32 s52, s50, 15
    s_add_u32 m0, s33, 16384
    s_add_u32 s34, s6, s52
    s_addc_u32 s35, s7, 0
    global_load_lds_dwordx4 v24, s[34:35]
    s_mul_i32 s52, s50, 88064
    s_add_u32 m0, s33, 19456
    s_add_u32 s64, s16, s52
    s_addc_u32 s65, s17, 0
    global_load_lds_dwordx4 v27, s[64:65]
    v_xor_b32 v12, 256, v11
    v_add_u32 v12, 162304, v12
    ds_read_b128 v[32:35], v10 offset:16384
    ds_read_b128 v[36:39], v12 offset:0
    v_xor_b32 v13, 16, v10
    ds_read_b128 v[40:43], v13 offset:16384
    ds_read_b128 v[44:47], v12 offset:16
    v_xor_b32 v13, 32, v10
    ds_read_b128 v[48:51], v13 offset:16384
    ds_read_b128 v[52:55], v12 offset:32
    v_xor_b32 v13, 48, v10
    ds_read_b128 v[56:59], v13 offset:16384
    ds_read_b128 v[60:63], v12 offset:48
    s_waitcnt lgkmcnt(6)
    v_dot2_f32_bf16 v14, v32, v36, v14
    v_dot2_f32_bf16 v15, v33, v37, v15
    v_dot2_f32_bf16 v14, v34, v38, v14
    v_dot2_f32_bf16 v15, v35, v39, v15
    s_waitcnt lgkmcnt(4)
    v_dot2_f32_bf16 v14, v40, v44, v14
    v_dot2_f32_bf16 v15, v41, v45, v15
    v_dot2_f32_bf16 v14, v42, v46, v14
    v_dot2_f32_bf16 v15, v43, v47, v15
    s_waitcnt lgkmcnt(2)
    v_dot2_f32_bf16 v14, v48, v52, v14
    v_dot2_f32_bf16 v15, v49, v53, v15
    v_dot2_f32_bf16 v14, v50, v54, v14
    v_dot2_f32_bf16 v15, v51, v55, v15
    s_waitcnt lgkmcnt(0)
    v_dot2_f32_bf16 v14, v56, v60, v14
    v_dot2_f32_bf16 v15, v57, v61, v15
    v_dot2_f32_bf16 v14, v58, v62, v14
    v_dot2_f32_bf16 v15, v59, v63, v15
    s_waitcnt vmcnt(4)
    s_barrier
    s_xor_b32 s50, s32, 10
    s_lshl_b32 s52, s50, 15
    s_add_u32 m0, s33, 32768
    s_add_u32 s34, s6, s52
    s_addc_u32 s35, s7, 0
    global_load_lds_dwordx4 v24, s[34:35]
    s_mul_i32 s52, s50, 88064
    s_add_u32 m0, s33, 35840
    s_add_u32 s64, s16, s52
    s_addc_u32 s65, s17, 0
    global_load_lds_dwordx4 v27, s[64:65]
    s_waitcnt vmcnt(4)
    s_barrier
    s_xor_b32 s50, s32, 11
    s_lshl_b32 s52, s50, 15
    s_add_u32 m0, s33, 49152
    s_add_u32 s34, s6, s52
    s_addc_u32 s35, s7, 0
    global_load_lds_dwordx4 v24, s[34:35]
    s_mul_i32 s52, s50, 88064
    s_add_u32 m0, s33, 52224
    s_add_u32 s64, s16, s52
    s_addc_u32 s65, s17, 0
    global_load_lds_dwordx4 v27, s[64:65]
    s_waitcnt vmcnt(4)
    s_barrier
    s_xor_b32 s50, s32, 12
    s_lshl_b32 s52, s50, 15
    s_add_u32 m0, s33, 0
    s_add_u32 s34, s6, s52
    s_addc_u32 s35, s7, 0
    global_load_lds_dwordx4 v24, s[34:35]
    s_mul_i32 s52, s50, 88064
    s_add_u32 m0, s33, 3072
    s_add_u32 s64, s16, s52
    s_addc_u32 s65, s17, 0
    global_load_lds_dwordx4 v27, s[64:65]
    v_xor_b32 v12, 512, v11
    v_add_u32 v12, 162304, v12
    ds_read_b128 v[32:35], v10 offset:32768
    ds_read_b128 v[36:39], v12 offset:0
    v_xor_b32 v13, 16, v10
    ds_read_b128 v[40:43], v13 offset:32768
    ds_read_b128 v[44:47], v12 offset:16
    v_xor_b32 v13, 32, v10
    ds_read_b128 v[48:51], v13 offset:32768
    ds_read_b128 v[52:55], v12 offset:32
    v_xor_b32 v13, 48, v10
    ds_read_b128 v[56:59], v13 offset:32768
    ds_read_b128 v[60:63], v12 offset:48
    s_waitcnt lgkmcnt(6)
    v_dot2_f32_bf16 v14, v32, v36, v14
    v_dot2_f32_bf16 v15, v33, v37, v15
    v_dot2_f32_bf16 v14, v34, v38, v14
    v_dot2_f32_bf16 v15, v35, v39, v15
    s_waitcnt lgkmcnt(4)
    v_dot2_f32_bf16 v14, v40, v44, v14
    v_dot2_f32_bf16 v15, v41, v45, v15
    v_dot2_f32_bf16 v14, v42, v46, v14
    v_dot2_f32_bf16 v15, v43, v47, v15
    s_waitcnt lgkmcnt(2)
    v_dot2_f32_bf16 v14, v48, v52, v14
    v_dot2_f32_bf16 v15, v49, v53, v15
    v_dot2_f32_bf16 v14, v50, v54, v14
    v_dot2_f32_bf16 v15, v51, v55, v15
    s_waitcnt lgkmcnt(0)
    v_dot2_f32_bf16 v14, v56, v60, v14
    v_dot2_f32_bf16 v15, v57, v61, v15
    v_dot2_f32_bf16 v14, v58, v62, v14
    v_dot2_f32_bf16 v15, v59, v63, v15
    s_waitcnt vmcnt(4)
    s_barrier
    global_load_dword v31, v30, s[26:27] sc1
    s_xor_b32 s50, s32, 13
    s_lshl_b32 s52, s50, 15
    s_add_u32 m0, s33, 16384
    s_add_u32 s34, s6, s52
    s_addc_u32 s35, s7, 0
    global_load_lds_dwordx4 v24, s[34:35]
    s_mul_i32 s52, s50, 88064
    s_add_u32 m0, s33, 19456
    s_add_u32 s64, s16, s52
    s_addc_u32 s65, s17, 0
    global_load_lds_dwordx4 v27, s[64:65]
    s_waitcnt vmcnt(5)
    s_barrier
    s_xor_b32 s50, s32, 14
    s_lshl_b32 s52, s50, 15
    s_add_u32 m0, s33, 32768
    s_add_u32 s34, s6, s52
    s_addc_u32 s35, s7, 0
    global_load_lds_dwordx4 v24, s[34:35]
    s_mul_i32 s52, s50, 88064
    s_add_u32 m0, s33, 35840
    s_add_u32 s64, s16, s52
    s_addc_u32 s65, s17, 0
    global_load_lds_dwordx4 v27, s[64:65]
    s_waitcnt vmcnt(5)
    s_barrier
    s_xor_b32 s50, s32, 15
    s_lshl_b32 s52, s50, 15
    s_add_u32 m0, s33, 49152
    s_add_u32 s34, s6, s52
    s_addc_u32 s35, s7, 0
    global_load_lds_dwordx4 v24, s[34:35]
    s_mul_i32 s52, s50, 88064
    s_add_u32 m0, s33, 52224
    s_add_u32 s64, s16, s52
    s_addc_u32 s65, s17, 0
    global_load_lds_dwordx4 v27, s[64:65]
    s_waitcnt vmcnt(4)
    s_barrier
    v_cmp_ne_u32 vcc, s58, v31
    s_mov_b32 s41, 0
    s_cbranch_vccnz L_slowp
    s_mov_b32 s41, 1
    s_add_u32 s50, s33, 0
    s_mov_b32 m0, s50
    s_add_u32 s66, s44, s50
    s_addc_u32 s67, s45, 0
    global_load_lds_dwordx4 v2, s[66:67] offset:0 sc1
    global_load_lds_dwordx4 v2, s[66:67] offset:1024 sc1
    global_load_lds_dwordx4 v2, s[66:67] offset:2048 sc1
    global_load_lds_dwordx4 v2, s[66:67] offset:3072 sc1
    v_xor_b32 v12, 768, v11
    v_add_u32 v12, 162304, v12
    ds_read_b128 v[32:35], v10 offset:49152
    ds_read_b128 v[36:39], v12 offset:0
    v_xor_b32 v13, 16, v10
    ds_read_b128 v[40:43], v13 offset:49152
    ds_read_b128 v[44:47], v12 offset:16
    v_xor_b32 v13, 32, v10
    ds_read_b128 v[48:51], v13 offset:49152
    ds_read_b128 v[52:55], v12 offset:32
    v_xor_b32 v13, 48, v10
    ds_read_b128 v[56:59], v13 offset:49152
    ds_read_b128 v[60:63], v12 offset:48
    s_waitcnt lgkmcnt(6)
    v_dot2_f32_bf16 v14, v32, v36, v14
    v_dot2_f32_bf16 v15, v33, v37, v15
    v_dot2_f32_bf16 v14, v34, v38, v14
    v_dot2_f32_bf16 v15, v35, v39, v15
    s_waitcnt lgkmcnt(4)
    v_dot2_f32_bf16 v14, v40, v44, v14
    v_dot2_f32_bf16 v15, v41, v45, v15
    v_dot2_f32_bf16 v14, v42, v46, v14
    v_dot2_f32_bf16 v15, v43, v47, v15
    s_waitcnt lgkmcnt(2)
    v_dot2_f32_bf16 v14, v48, v52, v14
    v_dot2_f32_bf16 v15, v49, v53, v15
    v_dot2_f32_bf16 v14, v50, v54, v14
    v_dot2_f32_bf16 v15, v51, v55, v15
    s_waitcnt lgkmcnt(0)
    v_dot2_f32_bf16 v14, v56, v60, v14
    v_dot2_f32_bf16 v15, v57, v61, v15
    v_dot2_f32_bf16 v14, v58, v62, v14
    v_dot2_f32_bf16 v15, v59, v63, v15
    s_waitcnt vmcnt(6)
    s_barrier
    s_add_u32 s50, s33, 16384
    s_mov_b32 m0, s50
    s_add_u32 s66, s44, s50
    s_addc_u32 s67, s45, 0
    global_load_lds_dwordx4 v2, s[66:67] offset:0 sc1
    global_load_lds_dwordx4 v2, s[66:67] offset:1024 sc1
    global_load_lds_dwordx4 v2, s[66:67] offset:2048 sc1
    global_load_lds_dwordx4 v2, s[66:67] offset:3072 sc1
    s_waitcnt vmcnt(8)
    s_barrier
    s_add_u32 s50, s33, 32768
    s_mov_b32 m0, s50
    s_add_u32 s66, s44, s50
    s_addc_u32 s67, s45, 0
    global_load_lds_dwordx4 v2, s[66:67] offset:0 sc1
    global_load_lds_dwordx4 v2, s[66:67] offset:1024 sc1
    global_load_lds_dwordx4 v2, s[66:67] offset:2048 sc1
    global_load_lds_dwordx4 v2, s[66:67] offset:3072 sc1
    s_branch L_g4
L_slowp:
    global_load_dword v31, v30, s[26:27] sc1
    v_xor_b32 v12, 768, v11
    v_add_u32 v12, 162304, v12
    ds_read_b128 v[32:35], v10 offset:49152
    ds_read_b128 v[36:39], v12 offset:0
    v_xor_b32 v13, 16, v10
    ds_read_b128 v[40:43], v13 offset:49152
    ds_read_b128 v[44:47], v12 offset:16
    v_xor_b32 v13, 32, v10
    ds_read_b128 v[48:51], v13 offset:49152
    ds_read_b128 v[52:55], v12 offset:32
    v_xor_b32 v13, 48, v10
    ds_read_b128 v[56:59], v13 offset:49152
    ds_read_b128 v[60:63], v12 offset:48
    s_waitcnt lgkmcnt(6)
    v_dot2_f32_bf16 v14, v32, v36, v14
    v_dot2_f32_bf16 v15, v33, v37, v15
    v_dot2_f32_bf16 v14, v34, v38, v14
    v_dot2_f32_bf16 v15, v35, v39, v15
    s_waitcnt lgkmcnt(4)
    v_dot2_f32_bf16 v14, v40, v44, v14
    v_dot2_f32_bf16 v15, v41, v45, v15
    v_dot2_f32_bf16 v14, v42, v46, v14
    v_dot2_f32_bf16 v15, v43, v47, v15
    s_waitcnt lgkmcnt(2)
    v_dot2_f32_bf16 v14, v48, v52, v14
    v_dot2_f32_bf16 v15, v49, v53, v15
    v_dot2_f32_bf16 v14, v50, v54, v14
    v_dot2_f32_bf16 v15, v51, v55, v15
    s_waitcnt lgkmcnt(0)
    v_dot2_f32_bf16 v14, v56, v60, v14
    v_dot2_f32_bf16 v15, v57, v61, v15
    v_dot2_f32_bf16 v14, v58, v62, v14
    v_dot2_f32_bf16 v15, v59, v63, v15
    s_waitcnt vmcnt(3)
    s_barrier
    s_waitcnt vmcnt(0)
    s_barrier
    v_cmp_ne_u32 vcc, s58, v31
    s_cbranch_vccnz L_g4
    s_mov_b32 s41, 1
    s_add_u32 s50, s33, 0
    s_mov_b32 m0, s50
    s_add_u32 s66, s44, s50
    s_addc_u32 s67, s45, 0
    global_load_lds_dwordx4 v2, s[66:67] offset:0 sc1
    global_load_lds_dwordx4 v2, s[66:67] offset:1024 sc1
    global_load_lds_dwordx4 v2, s[66:67] offset:2048 sc1
    global_load_lds_dwordx4 v2, s[66:67] offset:3072 sc1
    s_add_u32 s50, s33, 16384
    s_mov_b32 m0, s50
    s_add_u32 s66, s44, s50
    s_addc_u32 s67, s45, 0
    global_load_lds_dwordx4 v2, s[66:67] offset:0 sc1
    global_load_lds_dwordx4 v2, s[66:67] offset:1024 sc1
    global_load_lds_dwordx4 v2, s[66:67] offset:2048 sc1
    global_load_lds_dwordx4 v2, s[66:67] offset:3072 sc1
    s_add_u32 s50, s33, 32768
    s_mov_b32 m0, s50
    s_add_u32 s66, s44, s50
    s_addc_u32 s67, s45, 0
    global_load_lds_dwordx4 v2, s[66:67] offset:0 sc1
    global_load_lds_dwordx4 v2, s[66:67] offset:1024 sc1
    global_load_lds_dwordx4 v2, s[66:67] offset:2048 sc1
    global_load_lds_dwordx4 v2, s[66:67] offset:3072 sc1
    s_branch L_g4
L_aw:
    s_mul_i32 s42, s29, 6
    s_add_u32 s42, s42, s30
    s_sub_u32 s42, s42, 7
    s_mov_b32 s39, 2
    s_cmp_lg_u32 s29, 0
    s_cbranch_scc1 L_r1
    s_mov_b32 s42, 0
    s_cmp_lt_u32 s30, 7
    s_cselect_b32 s39, 3, 2
L_r1:
    s_cmp_lt_u32 s30, 2
    s_cselect_b32 s39, 0, s39
    s_cselect_b32 s50, 0, 512
    s_cselect_b32 s52, 1, 2
    s_cmp_ge_u32 s30, 6
    s_cselect_b32 s50, 1536, s50
    s_cselect_b32 s52, 1, s52
    s_lshl_b32 s52, s52, 9
    s_lshl_b32 s54, s30, 8
    s_add_u32 s50, s50, s54
    v_bfe_u32 v6, v1, 2, 2
    v_bfe_u32 v32, v1, 4, 1
    v_and_b32 v33, 3, v1
    v_lshlrev_b32 v6, 6, v6
    v_lshl_add_u32 v6, v32, 5, v6
    v_lshl_add_u32 v6, v33, 3, v6
    v_lshrrev_b32 v32, 5, v1
    v_lshl_add_u32 v6, v32, 12, v6
    v_add_u32 v6, s50, v6
    v_add_u32 v7, s52, v6
    v_and_b32 v33, 31, v1
    v_and_b32 v34, 15, v1
    v_xor_b32 v34, v34, v32
    v_lshlrev_b32 v34, 4, v34
    v_lshl_add_u32 v8, v33, 8, v34
    s_and_b32 s50, s32, 3
    s_lshl_b32 s50, s50, 6
    v_xor_b32 v8, s50, v8
    v_add_u32 v8, 66560, v8
    v_xor_b32 v9, 32, v8
    v_xor_b32 v10, 64, v8
    v_xor_b32 v11, 96, v8
    v_xor_b32 v12, 128, v8
    v_xor_b32 v13, 160, v8
    v_xor_b32 v14, 192, v8
    v_xor_b32 v15, 224, v8
    s_waitcnt lgkmcnt(0)
    s_load_dword s58, s[26:27], 0x33000
    s_lshl3_add_u32 s50, s28, s29
    s_lshl3_add_u32 s50, s50, s30
    s_lshl_b32 s50, s50, 10
    s_add_u32 s50, s50, 6291456
    s_add_u32 s48, s26, s50
    s_addc_u32 s49, s27, 0
    s_mul_i32 s50, s28, 43
    s_add_u32 s50, s50, s42
    s_lshl_b32 s50, s50, 12
    s_add_u32 s50, s50, 262144
    s_add_u32 s46, s26, s50
    s_addc_u32 s47, s27, 0
    s_cmp_lg_u32 s29, 0
    s_cbranch_scc1 L_nokv
    s_lshr_b32 s52, s30, 1
    s_and_b32 s54, s30, 1
    v_bfe_u32 v40, v1, 2, 2
    v_bfe_u32 v41, v1, 4, 1
    v_and_b32 v42, 3, v1
    v_lshlrev_b32 v40, 6, v40
    v_lshl_add_u32 v40, v41, 5, v40
    v_lshl_add_u32 v40, v42, 3, v40
    v_lshrrev_b32 v41, 5, v1
    v_lshl_add_u32 v40, v41, 9, v40
    s_lshr_b32 s50, s32, 2
    s_xor_b32 s50, s50, s52
    s_lshl_b32 s50, s50, 13
    s_add_u32 s50, s50, 32768
    v_add_u32 v40, s50, v40
    s_and_b32 s50, s32, 3
    s_lshl_b32 s50, s50, 6
    v_xor_b32 v41, s50, v8
    s_lshl1_add_u32 s50, s52, s54
    s_lshl_b32 s50, s50, 13
    v_add_u32 v41, s50, v41
    v_xor_b32 v42, 32, v41
    v_xor_b32 v43, 64, v41
    v_xor_b32 v44, 96, v41
    v_xor_b32 v45, 128, v41
    v_xor_b32 v46, 160, v41
    v_xor_b32 v47, 192, v41
    v_xor_b32 v48, 224, v41
    s_cmp_gt_u32 s52, 1
    s_subb_u32 s50, s52, 0
    s_cmp_eq_u32 s52, 1
    s_cselect_b32 s50, 0, s50
    s_mul_i32 s56, s54, 3
    s_add_u32 s50, s50, s56
    s_lshl_b32 s50, s50, 12
    s_add_u32 s50, s50, 133120
    v_add_u32 v50, s50, v2
    s_lshl1_add_u32 s50, s28, s54
    s_mul_i32 s50, s50, 2080
    s_add_u32 s66, s26, s50
    s_addc_u32 s67, s27, 0
    s_lshl_b32 s50, s54, 10
    s_add_u32 s50, s50, 157696
    v_and_b32 v52, 31, v1
    v_lshrrev_b32 v55, 5, v1
    v_lshlrev_b32 v52, 5, v52
    v_lshl_add_u32 v52, v55, 3, v52
    v_add_u32 v52, s50, v52
    v_bfe_u32 v53, v1, 2, 2
    v_bfe_u32 v54, v1, 4, 1
    v_lshl_add_u32 v53, v54, 3, v53
    v_lshl_add_u32 v53, v55, 4, v53
    v_lshlrev_b32 v53, 5, v53
    v_and_b32 v54, 3, v1
    v_lshl_add_u32 v53, v54, 3, v53
    v_add_u32 v53, s50, v53
    v_lshl_add_u32 v54, v55, 4, v2
    v_and_b32 v55, 1, v1
    v_mul_u32_u24 v55, 528, v55
    v_mov_b32 v56, 0x3f803f80
    v_mov_b32 v57, 0x3f803f80
    v_mov_b32 v58, 0x3f803f80
    v_mov_b32 v59, 0x3f803f80
    s_waitcnt lgkmcnt(0)
    s_barrier
    ds_read_b64_tr_b16 v[96:97], v40 offset:0
    ds_read_b64_tr_b16 v[98:99], v40 offset:256
    ds_read_b128 v[100:103], v41
    ds_read_b64_tr_b16 v[104:105], v40 offset:1024
    ds_read_b64_tr_b16 v[106:107], v40 offset:1280
    ds_read_b128 v[108:111], v42
    ds_read_b64_tr_b16 v[112:113], v40 offset:2048
    ds_read_b64_tr_b16 v[114:115], v40 offset:2304
    ds_read_b128 v[116:119], v43
    ds_read_b64_tr_b16 v[120:121], v40 offset:3072
    ds_read_b64_tr_b16 v[122:123], v40 offset:3328
    ds_read_b128 v[124:127], v44
    s_waitcnt lgkmcnt(9)
    v_mfma_f32_32x32x16_bf16 v[64:79], v[96:99], v[100:103], 0
    ds_read_b64_tr_b16 v[128:129], v40 offset:4096
    ds_read_b64_tr_b16 v[130:131], v40 offset:4352
    ds_read_b128 v[132:135], v45
    s_waitcnt lgkmcnt(9)
    v_mfma_f32_32x32x16_bf16 v[64:79], v[104:107], v[108:111], v[64:79]
    ds_read_b64_tr_b16 v[96:97], v40 offset:5120
    ds_read_b64_tr_b16 v[98:99], v40 offset:5376
    ds_read_b128 v[100:103], v46
    s_waitcnt lgkmcnt(9)
    v_mfma_f32_32x32x16_bf16 v[64:79], v[112:115], v[116:119], v[64:79]
    ds_read_b64_tr_b16 v[104:105], v40 offset:6144
    ds_read_b64_tr_b16 v[106:107], v40 offset:6400
    ds_read_b128 v[108:111], v47
    s_waitcnt lgkmcnt(9)
    v_mfma_f32_32x32x16_bf16 v[64:79], v[120:123], v[124:127], v[64:79]
    ds_read_b64_tr_b16 v[112:113], v40 offset:7168
    ds_read_b64_tr_b16 v[114:115], v40 offset:7424
    ds_read_b128 v[116:119], v48
    s_waitcnt lgkmcnt(9)
    v_mfma_f32_32x32x16_bf16 v[64:79], v[128:131], v[132:135], v[64:79]
    s_waitcnt lgkmcnt(6)
    v_mfma_f32_32x32x16_bf16 v[64:79], v[96:99], v[100:103], v[64:79]
    s_waitcnt lgkmcnt(3)
    v_mfma_f32_32x32x16_bf16 v[64:79], v[104:107], v[108:111], v[64:79]
    s_waitcnt lgkmcnt(0)
    v_mfma_f32_32x32x16_bf16 v[64:79], v[112:115], v[116:119], v[64:79]
    s_cmp_eq_u32 s52, 1
    s_cbranch_scc1 L_kvf
    s_nop 10
    ds_write_b128 v50, v[64:67] offset:0
    ds_write_b128 v50, v[68:71] offset:1024
    ds_write_b128 v50, v[72:75] offset:2048
    ds_write_b128 v50, v[76:79] offset:3072
    s_waitcnt lgkmcnt(0)
    s_barrier
    s_branch L_nokv
L_kvf:
    global_store_dwordx4 v55, v[56:59], s[66:67] offset:1536 sc1
    s_barrier
    ds_read_b128 v[80:83], v50 offset:0
    ds_read_b128 v[84:87], v50 offset:1024
    ds_read_b128 v[88:91], v50 offset:2048
    ds_read_b128 v[92:95], v50 offset:3072
    ds_read_b128 v[96:99], v50 offset:4096
    ds_read_b128 v[100:103], v50 offset:5120
    ds_read_b128 v[104:107], v50 offset:6144
    ds_read_b128 v[108:111], v50 offset:7168
    ds_read_b128 v[112:115], v50 offset:8192
    ds_read_b128 v[116:119], v50 offset:9216
    ds_read_b128 v[120:123], v50 offset:10240
    ds_read_b128 v[124:127], v50 offset:11264
    s_waitcnt lgkmcnt(8)
    v_pk_add_f32 v[64:65], v[64:65], v[80:81]
    v_pk_add_f32 v[66:67], v[66:67], v[82:83]
    v_pk_add_f32 v[68:69], v[68:69], v[84:85]
    v_pk_add_f32 v[70:71], v[70:71], v[86:87]
    v_pk_add_f32 v[72:73], v[72:73], v[88:89]
    v_pk_add_f32 v[74:75], v[74:75], v[90:91]
    v_pk_add_f32 v[76:77], v[76:77], v[92:93]
    v_pk_add_f32 v[78:79], v[78:79], v[94:95]
    s_waitcnt lgkmcnt(4)
    v_pk_add_f32 v[64:65], v[64:65], v[96:97]
    v_pk_add_f32 v[66:67], v[66:67], v[98:99]
    v_pk_add_f32 v[68:69], v[68:69], v[100:101]
    v_pk_add_f32 v[70:71], v[70:71], v[102:103]
    v_pk_add_f32 v[72:73], v[72:73], v[104:105]
    v_pk_add_f32 v[74:75], v[74:75], v[106:107]
    v_pk_add_f32 v[76:77], v[76:77], v[108:109]
    v_pk_add_f32 v[78:79], v[78:79], v[110:111]
    s_waitcnt lgkmcnt(0)
    v_pk_add_f32 v[64:65], v[64:65], v[112:113]
    v_pk_add_f32 v[66:67], v[66:67], v[114:115]
    v_pk_add_f32 v[68:69], v[68:69], v[116:117]
    v_pk_add_f32 v[70:71], v[70:71], v[118:119]
    v_pk_add_f32 v[72:73], v[72:73], v[120:121]
    v_pk_add_f32 v[74:75], v[74:75], v[122:123]
    v_pk_add_f32 v[76:77], v[76:77], v[124:125]
    v_pk_add_f32 v[78:79], v[78:79], v[126:127]
    v_cvt_pk_bf16_f32 v84, v72, v73
    v_cvt_pk_bf16_f32 v85, v74, v75
    v_cvt_pk_bf16_f32 v86, v76, v77
    v_cvt_pk_bf16_f32 v87, v78, v79
    ds_write_b64 v52, v[84:85]
    ds_write_b64 v52, v[86:87] offset:16
    ds_read_b64_tr_b16 v[88:89], v53
    ds_read_b64_tr_b16 v[90:91], v53 offset:128
    v_cvt_pk_bf16_f32 v80, v64, v65
    v_cvt_pk_bf16_f32 v81, v66, v67
    v_cvt_pk_bf16_f32 v82, v68, v69
    v_cvt_pk_bf16_f32 v83, v70, v71
    global_store_dwordx4 v2, v[80:83], s[66:67] sc1
    s_waitcnt lgkmcnt(0)
    global_store_dwordx4 v54, v[88:91], s[66:67] offset:1024 sc1
    s_barrier
    v_mov_b32 v128, -1
    v_mov_b32 v129, -1
    v_mov_b32 v130, -1
    v_mov_b32 v131, -1
    v_and_b32 v150, 15, v1
    v_lshrrev_b32 v151, 5, v1
    v_lshlrev_b32 v150, 4, v150
    v_lshl_add_u32 v150, v151, 8, v150
    v_and_b32 v151, 27, v1
    v_cmp_eq_u32 s[50:51], 0, v151
    v_cmp_lt_u32 vcc, 15, v151
    v_mov_b32 v151, 0x40000
    v_mov_b32 v152, 512
    v_cndmask_b32 v151, v151, v152, s[50:51]
    v_cndmask_b32 v148, v151, v150, vcc
    v_add_u32 v148, 1024, v148
    s_lshl_b32 s50, s30, 10
    s_add_u32 s50, s50, 133120
    v_add_u32 v149, s50, v2
    s_mov_b32 s63, 0
    v_mov_b32 v153, 0xdddddddd
    s_mov_b32 s62, 7
    v_mov_b32 v112, 0
    v_mov_b32 v113, 0
    v_mov_b32 v114, 0
    v_mov_b32 v115, 0
    v_mov_b32 v116, 0
    v_mov_b32 v117, 0
    v_mov_b32 v118, 0
    v_mov_b32 v119, 0
    v_mov_b32 v120, 0
    v_mov_b32 v121, 0
    v_mov_b32 v122, 0
    v_mov_b32 v123, 0
    v_mov_b32 v124, 0
    v_mov_b32 v125, 0
    v_mov_b32 v126, 0
    v_mov_b32 v127, 0
    s_barrier
    s_waitcnt vmcnt(0)
    s_barrier
    s_mov_b32 s61, 14
    s_cmp_lg_u32 s54, 0
    s_cbranch_scc1 L_idle1
    s_add_u32 s52, s58, 0x9e3779b1
    s_lshl_b32 s50, s28, 7
    s_add_u32 s50, s50, 200704
    v_mov_b32 v20, s50
    v_mov_b32 v21, s52
    s_mov_b64 exec, 1
    global_store_dword v20, v21, s[26:27] sc1
    s_mov_b64 exec, -1
    s_branch L_idle1
L_nokv:
    v_mov_b32 v128, -1
    v_mov_b32 v129, -1
    v_mov_b32 v130, -1
    v_mov_b32 v131, -1
    v_and_b32 v150, 15, v1
    v_lshrrev_b32 v151, 5, v1
    v_lshlrev_b32 v150, 4, v150
    v_lshl_add_u32 v150, v151, 8, v150
    v_and_b32 v151, 27, v1
    v_cmp_eq_u32 s[50:51], 0, v151
    v_cmp_lt_u32 vcc, 15, v151
    v_mov_b32 v151, 0x40000
    v_mov_b32 v152, 512
    v_cndmask_b32 v151, v151, v152, s[50:51]
    v_cndmask_b32 v148, v151, v150, vcc
    v_add_u32 v148, 1024, v148
    s_lshl_b32 s50, s30, 10
    s_add_u32 s50, s50, 133120
    v_add_u32 v149, s50, v2
    s_mov_b32 s63, 0
    v_mov_b32 v153, 0xdddddddd
    s_mov_b32 s62, 7
    v_mov_b32 v112, 0
    v_mov_b32 v113, 0
    v_mov_b32 v114, 0
    v_mov_b32 v115, 0
    v_mov_b32 v116, 0
    v_mov_b32 v117, 0
    v_mov_b32 v118, 0
    v_mov_b32 v119, 0
    v_mov_b32 v120, 0
    v_mov_b32 v121, 0
    v_mov_b32 v122, 0
    v_mov_b32 v123, 0
    v_mov_b32 v124, 0
    v_mov_b32 v125, 0
    v_mov_b32 v126, 0
    v_mov_b32 v127, 0
    v_mov_b32 v64, 0
    v_mov_b32 v65, 0
    v_mov_b32 v66, 0
    v_mov_b32 v67, 0
    v_mov_b32 v68, 0
    v_mov_b32 v69, 0
    v_mov_b32 v70, 0
    v_mov_b32 v71, 0
    v_mov_b32 v72, 0
    v_mov_b32 v73, 0
    v_mov_b32 v74, 0
    v_mov_b32 v75, 0
    v_mov_b32 v76, 0
    v_mov_b32 v77, 0
    v_mov_b32 v78, 0
    v_mov_b32 v79, 0
    v_mov_b32 v80, 0
    v_mov_b32 v81, 0
    v_mov_b32 v82, 0
    v_mov_b32 v83, 0
    v_mov_b32 v84, 0
    v_mov_b32 v85, 0
    v_mov_b32 v86, 0
    v_mov_b32 v87, 0
    v_mov_b32 v88, 0
    v_mov_b32 v89, 0
    v_mov_b32 v90, 0
    v_mov_b32 v91, 0
    v_mov_b32 v92, 0
    v_mov_b32 v93, 0
    v_mov_b32 v94, 0
    v_mov_b32 v95, 0
    v_mov_b32 v40, 0
    v_mov_b32 v41, 0
    v_mov_b32 v42, 0
    v_mov_b32 v43, 0
    v_mov_b32 v44, 0
    v_mov_b32 v45, 0
    v_mov_b32 v46, 0
    v_mov_b32 v47, 0
    v_mov_b32 v48, 0
    v_mov_b32 v49, 0
    v_mov_b32 v50, 0
    v_mov_b32 v51, 0
    v_mov_b32 v52, 0
    v_mov_b32 v53, 0
    v_mov_b32 v54, 0
    v_mov_b32 v55, 0
    v_mov_b32 v56, 0
    v_mov_b32 v57, 0
    v_mov_b32 v58, 0
    v_mov_b32 v59, 0
    v_mov_b32 v60, 0
    v_mov_b32 v61, 0
    v_mov_b32 v62, 0
    v_mov_b32 v63, 0
    s_mov_b32 s61, 4
    s_waitcnt lgkmcnt(0)
    s_cmp_eq_u32 s39, 3
    s_cbranch_scc1 L_idle
L_p1:
    s_barrier
    ds_read_b64_tr_b16 v[16:17], v6 offset:0
    ds_read_b64_tr_b16 v[18:19], v7 offset:0
    ds_read_b128 v[20:23], v8 offset:0
    ds_read_b128 v[24:27], v8 offset:8192
    v_add_u32 v8, 0x4000, v8
    ds_read_b64_tr_b16 v[28:29], v6 offset:8192
    ds_read_b64_tr_b16 v[30:31], v7 offset:8192
    ds_read_b128 v[32:35], v9 offset:0
    ds_read_b128 v[36:39], v9 offset:8192
    v_add_u32 v9, 0x4000, v9
    v_mfma_f32_32x32x16_bf16 v[64:79], v[40:43], v[44:47], v[64:79]
    v_mfma_f32_32x32x16_bf16 v[80:95], v[40:43], v[48:51], v[80:95]
    v_mfma_f32_32x32x16_bf16 v[64:79], v[52:55], v[56:59], v[64:79]
    v_mfma_f32_32x32x16_bf16 v[80:95], v[52:55], v[60:63], v[80:95]
    s_waitcnt lgkmcnt(0)
    s_barrier
    ds_read_b64_tr_b16 v[40:41], v6 offset:16384
    ds_read_b64_tr_b16 v[42:43], v7 offset:16384
    ds_read_b128 v[44:47], v10 offset:0
    ds_read_b128 v[48:51], v10 offset:8192
    v_add_u32 v10, 0x4000, v10
    ds_read_b64_tr_b16 v[52:53], v6 offset:24576
    ds_read_b64_tr_b16 v[54:55], v7 offset:24576
    ds_read_b128 v[56:59], v11 offset:0
    ds_read_b128 v[60:63], v11 offset:8192
    v_add_u32 v11, 0x4000, v11
    v_mfma_f32_32x32x16_bf16 v[64:79], v[16:19], v[20:23], v[64:79]
    v_mfma_f32_32x32x16_bf16 v[80:95], v[16:19], v[24:27], v[80:95]
    v_mfma_f32_32x32x16_bf16 v[64:79], v[28:31], v[32:35], v[64:79]
    v_mfma_f32_32x32x16_bf16 v[80:95], v[28:31], v[36:39], v[80:95]
    s_waitcnt lgkmcnt(0)
    s_barrier
    ds_read_b64_tr_b16 v[16:17], v6 offset:32768
    ds_read_b64_tr_b16 v[18:19], v7 offset:32768
    ds_read_b128 v[20:23], v12 offset:0
    ds_read_b128 v[24:27], v12 offset:8192
    v_add_u32 v12, 0x4000, v12
    ds_read_b64_tr_b16 v[28:29], v6 offset:40960
    ds_read_b64_tr_b16 v[30:31], v7 offset:40960
    ds_read_b128 v[32:35], v13 offset:0
    ds_read_b128 v[36:39], v13 offset:8192
    v_add_u32 v13, 0x4000, v13
    v_mfma_f32_32x32x16_bf16 v[64:79], v[40:43], v[44:47], v[64:79]
    v_mfma_f32_32x32x16_bf16 v[80:95], v[40:43], v[48:51], v[80:95]
    v_mfma_f32_32x32x16_bf16 v[64:79], v[52:55], v[56:59], v[64:79]
    v_mfma_f32_32x32x16_bf16 v[80:95], v[52:55], v[60:63], v[80:95]
    s_waitcnt lgkmcnt(0)
    s_barrier
    ds_read_b64_tr_b16 v[40:41], v6 offset:49152
    ds_read_b64_tr_b16 v[42:43], v7 offset:49152
    ds_read_b128 v[44:47], v14 offset:0
    ds_read_b128 v[48:51], v14 offset:8192
    v_add_u32 v14, 0x4000, v14
    ds_read_b64_tr_b16 v[52:53], v6 offset:57344
    ds_read_b64_tr_b16 v[54:55], v7 offset:57344
    ds_read_b128 v[56:59], v15 offset:0
    ds_read_b128 v[60:63], v15 offset:8192
    v_add_u32 v15, 0x4000, v15
    v_mfma_f32_32x32x16_bf16 v[64:79], v[16:19], v[20:23], v[64:79]
    v_mfma_f32_32x32x16_bf16 v[80:95], v[16:19], v[24:27], v[80:95]
    v_mfma_f32_32x32x16_bf16 v[64:79], v[28:31], v[32:35], v[64:79]
    v_mfma_f32_32x32x16_bf16 v[80:95], v[28:31], v[36:39], v[80:95]
    s_waitcnt lgkmcnt(0)
    s_sub_u32 s61, s61, 1
    s_cmp_lg_u32 s61, 0
    s_cbranch_scc1 L_p1
    s_barrier
    v_mfma_f32_32x32x16_bf16 v[64:79], v[40:43], v[44:47], v[64:79]
    v_mfma_f32_32x32x16_bf16 v[80:95], v[40:43], v[48:51], v[80:95]
    v_mfma_f32_32x32x16_bf16 v[64:79], v[52:55], v[56:59], v[64:79]
    v_mfma_f32_32x32x16_bf16 v[80:95], v[52:55], v[60:63], v[80:95]
    s_cmp_eq_u32 s39, 0
    s_mov_b32 s56, 0xbfb8aa3b
    s_cselect_b32 s56, 0x3eb8aa3b, s56
    s_mov_b32 s57, s56
    s_nop 7
    s_cbranch_scc0 L_epiH
    s_setprio 3
    v_pk_mul_f32 v[64:65], v[64:65], s[56:57]
    v_pk_mul_f32 v[66:67], v[66:67], s[56:57]
    v_pk_mul_f32 v[68:69], v[68:69], s[56:57]
    v_pk_mul_f32 v[70:71], v[70:71], s[56:57]
    v_pk_mul_f32 v[72:73], v[72:73], s[56:57]
    v_pk_mul_f32 v[74:75], v[74:75], s[56:57]
    v_pk_mul_f32 v[76:77], v[76:77], s[56:57]
    v_pk_mul_f32 v[78:79], v[78:79], s[56:57]
    v_pk_mul_f32 v[80:81], v[80:81], s[56:57]
    v_pk_mul_f32 v[82:83], v[82:83], s[56:57]
    v_pk_mul_f32 v[84:85], v[84:85], s[56:57]
    v_pk_mul_f32 v[86:87], v[86:87], s[56:57]
    v_pk_mul_f32 v[88:89], v[88:89], s[56:57]
    v_pk_mul_f32 v[90:91], v[90:91], s[56:57]
    v_pk_mul_f32 v[92:93], v[92:93], s[56:57]
    v_pk_mul_f32 v[94:95], v[94:95], s[56:57]
    v_cvt_pk_bf16_f32 v96, v64, v65
    v_cvt_pk_bf16_f32 v97, v66, v67
    v_cvt_pk_bf16_f32 v98, v68, v69
    v_cvt_pk_bf16_f32 v99, v70, v71
    v_cvt_pk_bf16_f32 v100, v72, v73
    v_cvt_pk_bf16_f32 v101, v74, v75
    v_cvt_pk_bf16_f32 v102, v76, v77
    v_cvt_pk_bf16_f32 v103, v78, v79
    v_cvt_pk_bf16_f32 v104, v80, v81
    v_cvt_pk_bf16_f32 v105, v82, v83
    v_cvt_pk_bf16_f32 v106, v84, v85
    v_cvt_pk_bf16_f32 v107, v86, v87
    v_cvt_pk_bf16_f32 v108, v88, v89
    v_cvt_pk_bf16_f32 v109, v90, v91
    v_cvt_pk_bf16_f32 v110, v92, v93
    v_cvt_pk_bf16_f32 v111, v94, v95
    s_lshl_b32 s50, s30, 12
    s_add_u32 s50, s50, 133120
    v_add_u32 v32, s50, v2
    ds_write_b128 v32, v[96:99] offset:0
    ds_write_b128 v32, v[100:103] offset:2048
    ds_write_b128 v32, v[104:107] offset:1024
    ds_write_b128 v32, v[108:111] offset:3072
    s_waitcnt lgkmcnt(0)
    v_mov_b32 v12, 162080
    v_mov_b32 v13, 1
    s_mov_b64 exec, 1
    ds_add_u32 v12, v13
    s_mov_b64 exec, -1
    s_branch L_p1done
L_idle:
    s_mov_b32 s61, 17
L_idle1:
    s_barrier
    s_sub_u32 s61, s61, 1
    s_cmp_lg_u32 s61, 0
    s_cbranch_scc1 L_idle1
    s_branch L_p1done
L_epiH:
    v_pk_mul_f32 v[96:97], v[64:65], s[56:57]
    v_pk_mul_f32 v[98:99], v[66:67], s[56:57]
    v_pk_mul_f32 v[100:101], v[68:69], s[56:57]
    v_pk_mul_f32 v[102:103], v[70:71], s[56:57]
    v_pk_mul_f32 v[104:105], v[72:73], s[56:57]
    v_pk_mul_f32 v[106:107], v[74:75], s[56:57]
    v_pk_mul_f32 v[108:109], v[76:77], s[56:57]
    v_pk_mul_f32 v[110:111], v[78:79], s[56:57]
    v_exp_f32 v96, v96
    v_exp_f32 v97, v97
    v_exp_f32 v98, v98
    v_exp_f32 v99, v99
    v_exp_f32 v100, v100
    v_exp_f32 v101, v101
    v_exp_f32 v102, v102
    v_exp_f32 v103, v103
    v_exp_f32 v104, v104
    v_exp_f32 v105, v105
    v_exp_f32 v106, v106
    v_exp_f32 v107, v107
    v_exp_f32 v108, v108
    v_exp_f32 v109, v109
    v_exp_f32 v110, v110
    v_exp_f32 v111, v111
    v_pk_add_f32 v[96:97], v[96:97], 1.0 op_sel_hi:[1,0]
    v_pk_add_f32 v[98:99], v[98:99], 1.0 op_sel_hi:[1,0]
    v_pk_add_f32 v[100:101], v[100:101], 1.0 op_sel_hi:[1,0]
    v_pk_add_f32 v[102:103], v[102:103], 1.0 op_sel_hi:[1,0]
    v_pk_add_f32 v[104:105], v[104:105], 1.0 op_sel_hi:[1,0]
    v_pk_add_f32 v[106:107], v[106:107], 1.0 op_sel_hi:[1,0]
    v_pk_add_f32 v[108:109], v[108:109], 1.0 op_sel_hi:[1,0]
    v_pk_add_f32 v[110:111], v[110:111], 1.0 op_sel_hi:[1,0]
    v_rcp_f32 v96, v96
    v_rcp_f32 v97, v97
    v_rcp_f32 v98, v98
    v_rcp_f32 v99, v99
    v_rcp_f32 v100, v100
    v_rcp_f32 v101, v101
    v_rcp_f32 v102, v102
    v_rcp_f32 v103, v103
    v_rcp_f32 v104, v104
    v_rcp_f32 v105, v105
    v_rcp_f32 v106, v106
    v_rcp_f32 v107, v107
    v_rcp_f32 v108, v108
    v_rcp_f32 v109, v109
    v_rcp_f32 v110, v110
    v_rcp_f32 v111, v111
    v_pk_mul_f32 v[96:97], v[96:97], v[64:65]
    v_pk_mul_f32 v[98:99], v[98:99], v[66:67]
    v_pk_mul_f32 v[100:101], v[100:101], v[68:69]
    v_pk_mul_f32 v[102:103], v[102:103], v[70:71]
    v_pk_mul_f32 v[104:105], v[104:105], v[72:73]
    v_pk_mul_f32 v[106:107], v[106:107], v[74:75]
    v_pk_mul_f32 v[108:109], v[108:109], v[76:77]
    v_pk_mul_f32 v[110:111], v[110:111], v[78:79]
    v_cvt_pk_bf16_f32 v132, v96, v97
    v_cvt_pk_bf16_f32 v133, v98, v99
    v_cvt_pk_bf16_f32 v134, v100, v101
    v_cvt_pk_bf16_f32 v135, v102, v103
    v_cvt_pk_bf16_f32 v136, v104, v105
    v_cvt_pk_bf16_f32 v137, v106, v107
    v_cvt_pk_bf16_f32 v138, v108, v109
    v_cvt_pk_bf16_f32 v139, v110, v111
    v_pk_mul_f32 v[96:97], v[80:81], s[56:57]
    v_pk_mul_f32 v[98:99], v[82:83], s[56:57]
    v_pk_mul_f32 v[100:101], v[84:85], s[56:57]
    v_pk_mul_f32 v[102:103], v[86:87], s[56:57]
    v_pk_mul_f32 v[104:105], v[88:89], s[56:57]
    v_pk_mul_f32 v[106:107], v[90:91], s[56:57]
    v_pk_mul_f32 v[108:109], v[92:93], s[56:57]
    v_pk_mul_f32 v[110:111], v[94:95], s[56:57]
    v_exp_f32 v96, v96
    v_exp_f32 v97, v97
    v_exp_f32 v98, v98
    v_exp_f32 v99, v99
    v_exp_f32 v100, v100
    v_exp_f32 v101, v101
    v_exp_f32 v102, v102
    v_exp_f32 v103, v103
    v_exp_f32 v104, v104
    v_exp_f32 v105, v105
    v_exp_f32 v106, v106
    v_exp_f32 v107, v107
    v_exp_f32 v108, v108
    v_exp_f32 v109, v109
    v_exp_f32 v110, v110
    v_exp_f32 v111, v111
    v_pk_add_f32 v[96:97], v[96:97], 1.0 op_sel_hi:[1,0]
    v_pk_add_f32 v[98:99], v[98:99], 1.0 op_sel_hi:[1,0]
    v_pk_add_f32 v[100:101], v[100:101], 1.0 op_sel_hi:[1,0]
    v_pk_add_f32 v[102:103], v[102:103], 1.0 op_sel_hi:[1,0]
    v_pk_add_f32 v[104:105], v[104:105], 1.0 op_sel_hi:[1,0]
    v_pk_add_f32 v[106:107], v[106:107], 1.0 op_sel_hi:[1,0]
    v_pk_add_f32 v[108:109], v[108:109], 1.0 op_sel_hi:[1,0]
    v_pk_add_f32 v[110:111], v[110:111], 1.0 op_sel_hi:[1,0]
    v_rcp_f32 v96, v96
    v_rcp_f32 v97, v97
    v_rcp_f32 v98, v98
    v_rcp_f32 v99, v99
    v_rcp_f32 v100, v100
    v_rcp_f32 v101, v101
    v_rcp_f32 v102, v102
    v_rcp_f32 v103, v103
    v_rcp_f32 v104, v104
    v_rcp_f32 v105, v105
    v_rcp_f32 v106, v106
    v_rcp_f32 v107, v107
    v_rcp_f32 v108, v108
    v_rcp_f32 v109, v109
    v_rcp_f32 v110, v110
    v_rcp_f32 v111, v111
    v_pk_mul_f32 v[96:97], v[96:97], v[80:81]
    v_pk_mul_f32 v[98:99], v[98:99], v[82:83]
    v_pk_mul_f32 v[100:101], v[100:101], v[84:85]
    v_pk_mul_f32 v[102:103], v[102:103], v[86:87]
    v_pk_mul_f32 v[104:105], v[104:105], v[88:89]
    v_pk_mul_f32 v[106:107], v[106:107], v[90:91]
    v_pk_mul_f32 v[108:109], v[108:109], v[92:93]
    v_pk_mul_f32 v[110:111], v[110:111], v[94:95]
    v_cvt_pk_bf16_f32 v140, v96, v97
    v_cvt_pk_bf16_f32 v141, v98, v99
    v_cvt_pk_bf16_f32 v142, v100, v101
    v_cvt_pk_bf16_f32 v143, v102, v103
    v_cvt_pk_bf16_f32 v144, v104, v105
    v_cvt_pk_bf16_f32 v145, v106, v107
    v_cvt_pk_bf16_f32 v146, v108, v109
    v_cvt_pk_bf16_f32 v147, v110, v111
L_p1done:
    v_mov_b32 v40, 0
    v_mov_b32 v41, 0
    v_mov_b32 v42, 0
    v_mov_b32 v43, 0
    v_mov_b32 v88, 0
    v_mov_b32 v89, 0
    v_mov_b32 v90, 0
    v_mov_b32 v91, 0
    v_mov_b32 v92, 0
    v_mov_b32 v93, 0
    v_mov_b32 v94, 0
    v_mov_b32 v95, 0
    v_mov_b32 v12, 162080
    s_mov_b32 s60, 4194304
L_b2a:
    ds_read_b32 v13, v12
    s_waitcnt lgkmcnt(0)
    v_readfirstlane_b32 s50, v13
    s_sub_u32 s60, s60, 1
    s_cmp_eq_u32 s60, 0
    s_cbranch_scc1 L_b2a_ok
    s_cmp_ge_u32 s50, 6
    s_cbranch_scc1 L_b2a_ok
    s_sleep 1
    s_branch L_b2a
L_b2a_ok:
    s_setprio 3
    ds_read_b128 v[16:19], v149
    ds_read_b128 v[20:23], v2
    ds_read_b128 v[24:27], v2 offset:2080
    ds_read_b128 v[28:31], v148
    ds_read_b128 v[32:35], v148 offset:2080
    ds_read_b128 v[36:39], v148 offset:528
    s_waitcnt lgkmcnt(4)
    v_mfma_f32_32x32x16_bf16 v[64:79], v[20:23], v[16:19], 0
    v_mov_b32 v12, 162084
    v_mov_b32 v13, 1
    s_mov_b64 exec, 1
    ds_add_u32 v12, v13
    s_mov_b64 exec, -1
    s_nop 6
    v_max3_f32 v12, v64, v65, v66
    v_max3_f32 v12, v12, v67, v68
    v_max3_f32 v12, v12, v69, v70
    v_max3_f32 v12, v12, v71, v72
    v_max3_f32 v12, v12, v73, v74
    v_max3_f32 v12, v12, v75, v76
    v_max3_f32 v12, v12, v77, v78
    v_max_f32 v12, v12, v79
L_att_setC:
    v_mov_b32 v14, v12
    v_mov_b32 v10, v2
    v_mov_b32 v11, v148
    v_permlane32_swap_b32 v12, v14
    s_mov_b32 s61, 0
    s_nop 0
    v_max_f32 v12, v12, v14
    v_sub_f32 v96, 0, v12
    v_sub_f32 v97, 0, v12
    v_sub_f32 v98, 0, v12
    v_sub_f32 v99, 0, v12
    v_sub_f32 v100, 0, v12
    v_sub_f32 v101, 0, v12
    v_sub_f32 v102, 0, v12
    v_sub_f32 v103, 0, v12
    v_sub_f32 v104, 0, v12
    v_sub_f32 v105, 0, v12
    v_sub_f32 v106, 0, v12
    v_sub_f32 v107, 0, v12
    v_sub_f32 v108, 0, v12
    v_sub_f32 v109, 0, v12
    v_sub_f32 v110, 0, v12
    v_sub_f32 v111, 0, v12
    s_waitcnt lgkmcnt(0)
    s_nop 0
    v_mfma_f32_32x32x16_bf16 v[64:79], v[20:23], v[16:19], v[96:111]
    ds_read_b128 v[20:23], v2 offset:4160
    s_setprio 2
    s_nop 9
.p2align 6
L_att_loop:
    v_exp_f32 v64, v64
    v_exp_f32 v65, v65
    v_smfmac_f32_32x32x32_bf16 v[112:127], v[40:43], v[88:95], v153
    ds_read_b128 v[40:43], v11 offset:2608
    v_exp_f32 v66, v66
    v_exp_f32 v67, v67
    v_exp_f32 v68, v68
    v_exp_f32 v69, v69
    v_exp_f32 v70, v70
    v_mfma_f32_32x32x16_bf16 v[80:95], v[24:27], v[16:19], v[96:111]
    ds_read_b128 v[24:27], v10 offset:6240
    v_exp_f32 v71, v71
    v_exp_f32 v72, v72
    v_exp_f32 v73, v73
    v_exp_f32 v74, v74
    v_exp_f32 v75, v75
    v_smfmac_f32_32x32x32_bf16 v[112:127], v[28:31], v[64:71], v153
    s_waitcnt lgkmcnt(2)
    ds_read_b128 v[28:31], v11 offset:4160
    v_exp_f32 v76, v76
    v_exp_f32 v77, v77
    v_exp_f32 v78, v78
    v_exp_f32 v79, v79
    v_exp_f32 v80, v80
    v_exp_f32 v81, v81
    v_smfmac_f32_32x32x32_bf16 v[112:127], v[36:39], v[72:79], v153
    ds_read_b128 v[36:39], v11 offset:4688
    v_exp_f32 v82, v82
    v_exp_f32 v83, v83
    v_exp_f32 v84, v84
    v_exp_f32 v85, v85
    v_exp_f32 v86, v86
    v_mfma_f32_32x32x16_bf16 v[64:79], v[20:23], v[16:19], v[96:111]
    ds_read_b128 v[20:23], v10 offset:8320
    v_exp_f32 v87, v87
    v_exp_f32 v88, v88
    v_exp_f32 v89, v89
    v_exp_f32 v90, v90
    v_exp_f32 v91, v91
    v_smfmac_f32_32x32x32_bf16 v[112:127], v[32:35], v[80:87], v153
    s_waitcnt lgkmcnt(2)
    ds_read_b128 v[32:35], v11 offset:6240
    v_exp_f32 v92, v92
    v_exp_f32 v93, v93
    v_exp_f32 v94, v94
    v_exp_f32 v95, v95
    v_exp_f32 v64, v64
    v_exp_f32 v65, v65
    v_smfmac_f32_32x32x32_bf16 v[112:127], v[40:43], v[88:95], v153
    ds_read_b128 v[40:43], v11 offset:6768
    v_exp_f32 v66, v66
    v_exp_f32 v67, v67
    v_exp_f32 v68, v68
    v_exp_f32 v69, v69
    v_exp_f32 v70, v70
    v_mfma_f32_32x32x16_bf16 v[80:95], v[24:27], v[16:19], v[96:111]
    ds_read_b128 v[24:27], v10 offset:10400
    v_exp_f32 v71, v71
    v_exp_f32 v72, v72
    v_exp_f32 v73, v73
    v_exp_f32 v74, v74
    v_exp_f32 v75, v75
    v_smfmac_f32_32x32x32_bf16 v[112:127], v[28:31], v[64:71], v153
    s_waitcnt lgkmcnt(2)
    ds_read_b128 v[28:31], v11 offset:8320
    v_exp_f32 v76, v76
    v_exp_f32 v77, v77
    v_exp_f32 v78, v78
    v_exp_f32 v79, v79
    v_exp_f32 v80, v80
    v_exp_f32 v81, v81
    v_smfmac_f32_32x32x32_bf16 v[112:127], v[36:39], v[72:79], v153
    ds_read_b128 v[36:39], v11 offset:8848
    v_exp_f32 v82, v82
    v_exp_f32 v83, v83
    v_exp_f32 v84, v84
    v_exp_f32 v85, v85
    v_exp_f32 v86, v86
    v_mfma_f32_32x32x16_bf16 v[64:79], v[20:23], v[16:19], v[96:111]
    ds_read_b128 v[20:23], v10 offset:12480
    v_exp_f32 v87, v87
    v_exp_f32 v88, v88
    v_exp_f32 v89, v89
    v_exp_f32 v90, v90
    v_exp_f32 v91, v91
    v_smfmac_f32_32x32x32_bf16 v[112:127], v[32:35], v[80:87], v153
    s_waitcnt lgkmcnt(2)
    ds_read_b128 v[32:35], v11 offset:10400
    v_exp_f32 v92, v92
    v_exp_f32 v93, v93
    v_exp_f32 v94, v94
    v_exp_f32 v95, v95
    v_exp_f32 v64, v64
    v_exp_f32 v65, v65
    v_smfmac_f32_32x32x32_bf16 v[112:127], v[40:43], v[88:95], v153
    ds_read_b128 v[40:43], v11 offset:10928
    v_exp_f32 v66, v66
    v_exp_f32 v67, v67
    v_exp_f32 v68, v68
    v_exp_f32 v69, v69
    v_exp_f32 v70, v70
    v_mfma_f32_32x32x16_bf16 v[80:95], v[24:27], v[16:19], v[96:111]
    ds_read_b128 v[24:27], v10 offset:14560
    v_exp_f32 v71, v71
    v_exp_f32 v72, v72
    v_exp_f32 v73, v73
    v_exp_f32 v74, v74
    v_exp_f32 v75, v75
    v_smfmac_f32_32x32x32_bf16 v[112:127], v[28:31], v[64:71], v153
    s_waitcnt lgkmcnt(2)
    ds_read_b128 v[28:31], v11 offset:12480
    v_exp_f32 v76, v76
    v_exp_f32 v77, v77
    v_exp_f32 v78, v78
    v_exp_f32 v79, v79
    s_bitcmp1_b32 s62, s61
    s_cbranch_scc1 L_att_chk
L_att_chk_ret:
    v_exp_f32 v80, v80
    v_exp_f32 v81, v81
    v_smfmac_f32_32x32x32_bf16 v[112:127], v[36:39], v[72:79], v153
    ds_read_b128 v[36:39], v11 offset:13008
    v_exp_f32 v82, v82
    v_exp_f32 v83, v83
    v_exp_f32 v84, v84
    v_exp_f32 v85, v85
    v_exp_f32 v86, v86
    v_mfma_f32_32x32x16_bf16 v[64:79], v[20:23], v[16:19], v[96:111]
    ds_read_b128 v[20:23], v10 offset:16640
    v_exp_f32 v87, v87
    v_exp_f32 v88, v88
    v_exp_f32 v89, v89
    v_exp_f32 v90, v90
    v_exp_f32 v91, v91
    v_smfmac_f32_32x32x32_bf16 v[112:127], v[32:35], v[80:87], v153
    s_waitcnt lgkmcnt(2)
    ds_read_b128 v[32:35], v11 offset:14560
    v_exp_f32 v92, v92
    v_exp_f32 v93, v93
    v_exp_f32 v94, v94
    v_exp_f32 v95, v95
    v_exp_f32 v64, v64
    v_exp_f32 v65, v65
    v_smfmac_f32_32x32x32_bf16 v[112:127], v[40:43], v[88:95], v153
    ds_read_b128 v[40:43], v11 offset:15088
    v_exp_f32 v66, v66
    v_exp_f32 v67, v67
    v_exp_f32 v68, v68
    v_exp_f32 v69, v69
    v_exp_f32 v70, v70
    v_mfma_f32_32x32x16_bf16 v[80:95], v[24:27], v[16:19], v[96:111]
    ds_read_b128 v[24:27], v10 offset:18720
    v_exp_f32 v71, v71
    v_exp_f32 v72, v72
    v_exp_f32 v73, v73
    v_exp_f32 v74, v74
    v_exp_f32 v75, v75
    v_smfmac_f32_32x32x32_bf16 v[112:127], v[28:31], v[64:71], v153
    s_waitcnt lgkmcnt(2)
    ds_read_b128 v[28:31], v11 offset:16640
    v_exp_f32 v76, v76
    v_exp_f32 v77, v77
    v_exp_f32 v78, v78
    v_exp_f32 v79, v79
    v_exp_f32 v80, v80
    v_exp_f32 v81, v81
    v_smfmac_f32_32x32x32_bf16 v[112:127], v[36:39], v[72:79], v153
    ds_read_b128 v[36:39], v11 offset:17168
    v_exp_f32 v82, v82
    v_exp_f32 v83, v83
    v_exp_f32 v84, v84
    v_exp_f32 v85, v85
    v_exp_f32 v86, v86
    v_mfma_f32_32x32x16_bf16 v[64:79], v[20:23], v[16:19], v[96:111]
    ds_read_b128 v[20:23], v10 offset:20800
    v_exp_f32 v87, v87
    v_exp_f32 v88, v88
    v_exp_f32 v89, v89
    v_exp_f32 v90, v90
    v_exp_f32 v91, v91
    v_smfmac_f32_32x32x32_bf16 v[112:127], v[32:35], v[80:87], v153
    s_waitcnt lgkmcnt(2)
    ds_read_b128 v[32:35], v11 offset:18720
    v_exp_f32 v92, v92
    v_exp_f32 v93, v93
    v_exp_f32 v94, v94
    v_exp_f32 v95, v95
    v_add_u32 v10, 16640, v10
    v_add_u32 v11, 16640, v11
    s_add_u32 s61, s61, 1
    s_cmp_lt_u32 s61, 6
    s_cbranch_scc1 L_att_loop
    s_setprio 0
    s_cmp_lt_u32 s61, 8
    s_cbranch_scc1 L_att_loop
    s_setprio 3
    s_and_b32 s50, s30, 1
    s_lshl_b32 s50, s50, 7
    v_smfmac_f32_32x32x32_bf16 v[112:127], v[40:43], v[88:95], v153
    s_add_u32 s50, s50, 161792
    v_and_b32 v12, 31, v1
    v_lshl_add_u32 v12, v12, 2, s50
    ds_read_b32 v14, v12
    s_mov_b32 s50, 0x6a800000
    v_mov_b32 v13, 0x207
    s_nop 6
    v_mul_f32 v12, s50, v112
    v_add_f32 v12, v12, abs(v120)
    v_add_f32 v12, v12, abs(v121)
    v_add_f32 v12, v12, abs(v122)
    v_add_f32 v12, v12, abs(v123)
    v_add_f32 v12, v12, abs(v124)
    v_add_f32 v12, v12, abs(v125)
    v_add_f32 v12, v12, abs(v126)
    v_add_f32 v12, v12, abs(v127)
    v_cmp_class_f32 vcc, v12, v13
    v_rcp_f32 v12, v112
    s_cbranch_vccz L_att_ok
    s_cmp_eq_u32 s63, 0
    s_cbranch_scc1 L_att_truemax
L_att_ok:
    s_waitcnt lgkmcnt(0)
    v_mul_f32 v12, v12, v14
    v_mul_f32 v120, v120, v12
    v_mul_f32 v121, v121, v12
    v_mul_f32 v122, v122, v12
    v_mul_f32 v123, v123, v12
    v_mul_f32 v124, v124, v12
    v_mul_f32 v125, v125, v12
    v_mul_f32 v126, v126, v12
    v_mul_f32 v127, v127, v12
    v_cvt_pk_bf16_f32 v48, v120, v121
    v_cvt_pk_bf16_f32 v49, v122, v123
    v_cvt_pk_bf16_f32 v50, v124, v125
    v_cvt_pk_bf16_f32 v51, v126, v127
    v_min_u32 v48, -2, v48
    v_min_u32 v49, -2, v49
    v_min_u32 v50, -2, v50
    v_min_u32 v51, -2, v51
    global_store_dwordx4 v2, v[48:51], s[48:49] sc1
    v_mov_b32 v12, 162076
    v_mov_b32 v13, 1
    s_mov_b64 exec, 1
    ds_add_u32 v12, v13
    s_mov_b64 exec, -1
    s_branch L_fin
L_att_chk:
    s_cmp_eq_u32 s61, 1
    s_cbranch_scc1 L_att_chk1
    s_lshl1_add_u32 s52, s61, 0
    s_add_u32 s52, s52, 162048
    v_mov_b32 v12, s52
    s_mov_b32 s60, 4194304
L_att_chk2:
    ds_read_b32 v13, v12
    s_waitcnt lgkmcnt(0)
    v_readfirstlane_b32 s50, v13
    s_sub_u32 s60, s60, 1
    s_cmp_eq_u32 s60, 0
    s_cbranch_scc1 L_att_chk2_ok
    s_cmp_ge_u32 s50, 4
    s_cbranch_scc1 L_att_chk2_ok
    s_sleep 1
    s_branch L_att_chk2
L_att_chk2_ok:
    s_cmp_lg_u32 s61, 0
    s_cbranch_scc1 L_att_chk_ret
    global_store_dwordx4 v2, v[128:131], s[48:49] sc1
    s_cmp_lg_u32 s39, 2
    s_cbranch_scc1 L_att_chk_ret
    global_store_dwordx4 v2, v[132:135], s[46:47] offset:0 sc1
    global_store_dwordx4 v2, v[136:139], s[46:47] offset:2048 sc1
    global_store_dwordx4 v2, v[140:143], s[46:47] offset:1024 sc1
    global_store_dwordx4 v2, v[144:147], s[46:47] offset:3072 sc1
    s_branch L_att_chk_ret
L_att_chk1:
    s_waitcnt vmcnt(0)
    v_mov_b32 v12, 162072
    v_mov_b32 v13, 1
    s_mov_b64 exec, 1
    ds_add_rtn_u32 v13, v12, v13
    s_lshl_b32 s50, s28, 7
    s_lshl2_add_u32 s50, s29, s50
    s_add_u32 s50, s50, 196608
    s_add_u32 s52, s58, 0x9e3779b1
    s_waitcnt lgkmcnt(0)
    v_cmp_eq_u32 vcc, 7, v13
    s_cbranch_vccz L_att_chk1b
    v_mov_b32 v12, s50
    v_mov_b32 v13, s52
    global_store_dword v12, v13, s[26:27] sc1
L_att_chk1b:
    s_mov_b64 exec, -1
    s_setprio 1
    s_branch L_att_chk_ret
L_att_truemax:
    s_mov_b32 s63, 1
    s_mov_b32 s62, 0
    v_mov_b32 v12, 0xff800000
    v_mov_b32 v10, v2
    s_mov_b32 s61, 0
L_att_tm:
    ds_read_b128 v[20:23], v10
    v_add_u32 v10, 2080, v10
    s_waitcnt lgkmcnt(0)
    v_mfma_f32_32x32x16_bf16 v[64:79], v[20:23], v[16:19], 0
    s_nop 15
    v_max3_f32 v12, v12, v64, v65
    v_max3_f32 v12, v12, v66, v67
    v_max3_f32 v12, v12, v68, v69
    v_max3_f32 v12, v12, v70, v71
    v_max3_f32 v12, v12, v72, v73
    v_max3_f32 v12, v12, v74, v75
    v_max3_f32 v12, v12, v76, v77
    v_max3_f32 v12, v12, v78, v79
    s_add_u32 s61, s61, 1
    s_cmp_lt_u32 s61, 64
    s_cbranch_scc1 L_att_tm
    ds_read_b128 v[20:23], v2
    ds_read_b128 v[24:27], v2 offset:2080
    ds_read_b128 v[28:31], v148
    ds_read_b128 v[32:35], v148 offset:2080
    ds_read_b128 v[36:39], v148 offset:528
    v_mov_b32 v112, 0
    v_mov_b32 v113, 0
    v_mov_b32 v114, 0
    v_mov_b32 v115, 0
    v_mov_b32 v116, 0
    v_mov_b32 v117, 0
    v_mov_b32 v118, 0
    v_mov_b32 v119, 0
    v_mov_b32 v120, 0
    v_mov_b32 v121, 0
    v_mov_b32 v122, 0
    v_mov_b32 v123, 0
    v_mov_b32 v124, 0
    v_mov_b32 v125, 0
    v_mov_b32 v126, 0
    v_mov_b32 v127, 0
    v_mov_b32 v40, 0
    v_mov_b32 v41, 0
    v_mov_b32 v42, 0
    v_mov_b32 v43, 0
    v_mov_b32 v88, 0
    v_mov_b32 v89, 0
    v_mov_b32 v90, 0
    v_mov_b32 v91, 0
    v_mov_b32 v92, 0
    v_mov_b32 v93, 0
    v_mov_b32 v94, 0
    v_mov_b32 v95, 0
    s_branch L_att_setC
L_g4:
    s_setprio 3
    v_add_f32 v14, v14, v15
    s_nop 1
    v_add_f32_dpp v14, v14, v14 quad_perm:[1,0,3,2] row_mask:0xf bank_mask:0xf
    s_nop 1
    v_add_f32_dpp v14, v14, v14 quad_perm:[2,3,0,1] row_mask:0xf bank_mask:0xf
    v_mul_f32 v14, 0xbfb8aa3b, v14
    v_exp_f32 v14, v14
    s_lshl_b32 s50, s31, 6
    s_add_u32 s50, s50, 161792
    v_add_f32 v14, 1.0, v14
    v_rcp_f32 v14, v14
    v_and_b32 v12, 60, v1
    v_add_u32 v12, s50, v12
    ds_write_b32 v12, v14
    s_barrier
    s_cmp_lg_u32 s41, 0
    s_cbranch_scc1 L_kvfast
    s_mov_b32 s60, 65536
L_kvpoll:
    global_load_dword v31, v30, s[26:27] sc1
    s_waitcnt vmcnt(0)
    v_cmp_ne_u32 vcc, s58, v31
    s_cbranch_vccz L_kvpoll_ok
    s_sleep 4
    s_sub_u32 s60, s60, 1
    s_cmp_lg_u32 s60, 0
    s_cbranch_scc1 L_kvpoll
L_kvpoll_ok:
    s_add_u32 s50, s33, 0
    s_mov_b32 m0, s50
    s_add_u32 s66, s44, s50
    s_addc_u32 s67, s45, 0
    global_load_lds_dwordx4 v2, s[66:67] offset:0 sc1
    global_load_lds_dwordx4 v2, s[66:67] offset:1024 sc1
    global_load_lds_dwordx4 v2, s[66:67] offset:2048 sc1
    global_load_lds_dwordx4 v2, s[66:67] offset:3072 sc1
    s_add_u32 s50, s33, 16384
    s_mov_b32 m0, s50
    s_add_u32 s66, s44, s50
    s_addc_u32 s67, s45, 0
    global_load_lds_dwordx4 v2, s[66:67] offset:0 sc1
    global_load_lds_dwordx4 v2, s[66:67] offset:1024 sc1
    global_load_lds_dwordx4 v2, s[66:67] offset:2048 sc1
    global_load_lds_dwordx4 v2, s[66:67] offset:3072 sc1
    s_add_u32 s50, s33, 32768
    s_mov_b32 m0, s50
    s_add_u32 s66, s44, s50
    s_addc_u32 s67, s45, 0
    global_load_lds_dwordx4 v2, s[66:67] offset:0 sc1
    global_load_lds_dwordx4 v2, s[66:67] offset:1024 sc1
    global_load_lds_dwordx4 v2, s[66:67] offset:2048 sc1
    global_load_lds_dwordx4 v2, s[66:67] offset:3072 sc1
L_kvfast:
    s_add_u32 s50, s33, 49152
    s_mov_b32 m0, s50
    s_add_u32 s66, s44, s50
    s_addc_u32 s67, s45, 0
    global_load_lds_dwordx4 v2, s[66:67] offset:0 sc1
    global_load_lds_dwordx4 v2, s[66:67] offset:1024 sc1
    global_load_lds_dwordx4 v2, s[66:67] offset:2048 sc1
    global_load_lds_dwordx4 v2, s[66:67] offset:3072 sc1
    s_waitcnt vmcnt(8)
    v_mov_b32 v12, 162080
    v_mov_b32 v13, 1
    s_mov_b64 exec, 1
    ds_add_u32 v12, v13
    s_mov_b64 exec, -1
    s_lshl_b32 s54, s31, 14
    s_add_u32 s50, s54, 65536
    s_mov_b32 m0, s50
    s_add_u32 s66, s44, s50
    s_addc_u32 s67, s45, 0
    global_load_lds_dwordx4 v2, s[66:67] offset:0 sc1
    global_load_lds_dwordx4 v2, s[66:67] offset:1024 sc1
    global_load_lds_dwordx4 v2, s[66:67] offset:2048 sc1
    global_load_lds_dwordx4 v2, s[66:67] offset:3072 sc1
    s_waitcnt vmcnt(4)
    v_mov_b32 v12, 162048
    v_mov_b32 v13, 1
    s_mov_b64 exec, 1
    ds_add_u32 v12, v13
    s_mov_b64 exec, -1
    s_add_u32 s50, s54, 69632
    s_mov_b32 m0, s50
    s_add_u32 s66, s44, s50
    s_addc_u32 s67, s45, 0
    global_load_lds_dwordx4 v2, s[66:67] offset:0 sc1
    global_load_lds_dwordx4 v2, s[66:67] offset:1024 sc1
    global_load_lds_dwordx4 v2, s[66:67] offset:2048 sc1
    global_load_lds_dwordx4 v2, s[66:67] offset:3072 sc1
    s_add_u32 s50, s54, 73728
    s_mov_b32 m0, s50
    s_add_u32 s66, s44, s50
    s_addc_u32 s67, s45, 0
    global_load_lds_dwordx4 v2, s[66:67] offset:0 sc1
    global_load_lds_dwordx4 v2, s[66:67] offset:1024 sc1
    global_load_lds_dwordx4 v2, s[66:67] offset:2048 sc1
    global_load_lds_dwordx4 v2, s[66:67] offset:3072 sc1
    s_add_u32 s50, s54, 77824
    s_mov_b32 m0, s50
    s_add_u32 s66, s44, s50
    s_addc_u32 s67, s45, 0
    global_load_lds_dwordx4 v2, s[66:67] offset:0 sc1
    global_load_lds_dwordx4 v2, s[66:67] offset:1024 sc1
    global_load_lds_dwordx4 v2, s[66:67] offset:2048 sc1
    global_load_lds_dwordx4 v2, s[66:67] offset:3072 sc1
    s_cmp_lg_u32 s31, 0
    s_cbranch_scc1 L_g5
    s_mov_b32 m0, 131072
    s_add_u32 s66, s44, 0x20000
    s_addc_u32 s67, s45, 0
    global_load_lds_dwordx4 v2, s[66:67] sc1
    s_mov_b32 m0, 132096
    s_add_u32 s66, s44, 0x20400
    s_addc_u32 s67, s45, 0
    global_load_lds_dwordx4 v2, s[66:67] sc1
L_g5:
    v_bfe_u32 v7, v1, 2, 2
    v_bfe_u32 v32, v1, 4, 1
    v_and_b32 v33, 3, v1
    v_lshlrev_b32 v7, 6, v7
    v_lshl_add_u32 v7, v32, 5, v7
    v_lshl_add_u32 v7, v33, 3, v7
    v_lshrrev_b32 v32, 5, v1
    v_lshl_add_u32 v7, v32, 9, v7
    s_lshl_b32 s50, s28, 7
    s_add_u32 s50, s50, 196608
    s_add_u32 s36, s26, s50
    s_addc_u32 s37, s27, 0
    s_mul_i32 s50, s28, 176128
    s_add_u32 s50, s50, 262144
    s_add_u32 s46, s26, s50
    s_addc_u32 s47, s27, 0
    s_lshl2_add_u32 s50, s28, s31
    s_lshl_b32 s50, s50, 14
    s_add_u32 s50, s50, 6291456
    s_add_u32 s48, s26, s50
    s_addc_u32 s49, s27, 0
    v_lshrrev_b32 v32, 5, v1
    v_bfe_u32 v33, v1, 2, 2
    v_lshl_add_u32 v32, v32, 2, v33
    v_lshlrev_b32 v8, 10, v32
    v_bfe_u32 v33, v1, 4, 1
    v_lshl_add_u32 v8, v33, 6, v8
    v_and_b32 v33, 3, v1
    v_lshl_add_u32 v8, v33, 4, v8
    v_add_u32 v9, 0x2000, v8
    s_mul_i32 s40, s31, 6144
    s_add_u32 s40, s40, 133120
    v_add_u32 v3, s40, v7
    s_lshr_b32 s50, s31, 1
    s_lshl_b32 s50, s50, 8
    v_add_u32 v3, s50, v3
    v_xor_b32 v10, 0x100, v3
    s_and_b32 s50, s31, 1
    s_lshl_b32 s50, s50, 10
    v_add_u32 v11, s50, v2
    v_xor_b32 v0, 0x400, v11
    s_waitcnt vmcnt(0)
    v_mov_b32 v12, 162052
    v_mov_b32 v13, 1
    s_mov_b64 exec, 1
    ds_add_u32 v12, v13
    s_mov_b64 exec, -1
    s_and_b32 s50, s28, 7
    s_lshl_b32 s52, s31, 9
    s_add_u32 s50, s50, s52
    v_lshl_add_u32 v12, v1, 3, s50
    v_min_u32 v12, 1375, v12
    s_lshl_b32 s50, s29, 7
    v_lshl_add_u32 v12, v12, 10, s50
    global_load_dword v14, v12, s[18:19]
    v_mov_b32 v12, 162084
    s_mov_b32 s60, 4194304
L_qr:
    ds_read_b32 v13, v12
    s_waitcnt lgkmcnt(0)
    v_readfirstlane_b32 s50, v13
    s_sub_u32 s60, s60, 1
    s_cmp_eq_u32 s60, 0
    s_cbranch_scc1 L_qr_ok
    s_cmp_ge_u32 s50, 8
    s_cbranch_scc1 L_qr_ok
    s_sleep 4
    s_branch L_qr
L_qr_ok:
    s_waitcnt vmcnt(0)
    s_lshl_b32 s50, s31, 17
    s_lshl_b32 s52, s29, 7
    s_add_u32 s50, s50, s52
    s_add_u32 s66, s12, s50
    s_addc_u32 s67, s13, 0
    s_add_u32 m0, s40, 0
    s_nop 0
    global_load_lds_dwordx4 v8, s[66:67]
    s_add_u32 m0, s40, 1024
    s_nop 0
    global_load_lds_dwordx4 v9, s[66:67]
    s_add_u32 s66, s66, 0x4000
    s_addc_u32 s67, s67, 0
    s_add_u32 m0, s40, 2048
    s_nop 0
    global_load_lds_dwordx4 v8, s[66:67]
    s_add_u32 m0, s40, 3072
    s_nop 0
    global_load_lds_dwordx4 v9, s[66:67]
    s_add_u32 s66, s66, 0x4000
    s_addc_u32 s67, s67, 0
    s_add_u32 m0, s40, 4096
    s_nop 0
    global_load_lds_dwordx4 v8, s[66:67]
    s_add_u32 m0, s40, 5120
    s_nop 0
    global_load_lds_dwordx4 v9, s[66:67]
    s_add_u32 s66, s66, 0x4000
    s_addc_u32 s67, s67, 0
    s_waitcnt vmcnt(4)
    ds_read_b64_tr_b16 v[36:37], v3 offset:0
    ds_read_b64_tr_b16 v[38:39], v3 offset:1024
    ds_read_b64_tr_b16 v[40:41], v10 offset:0
    ds_read_b64_tr_b16 v[42:43], v10 offset:1024
    s_waitcnt lgkmcnt(0)
    s_add_u32 m0, s40, 0
    s_nop 0
    global_load_lds_dwordx4 v8, s[66:67]
    s_add_u32 m0, s40, 1024
    s_nop 0
    global_load_lds_dwordx4 v9, s[66:67]
    s_add_u32 s66, s66, 0x4000
    s_addc_u32 s67, s67, 0
    s_waitcnt vmcnt(4)
    ds_read_b64_tr_b16 v[44:45], v3 offset:2048
    ds_read_b64_tr_b16 v[46:47], v3 offset:3072
    ds_read_b64_tr_b16 v[48:49], v10 offset:2048
    ds_read_b64_tr_b16 v[50:51], v10 offset:3072
    s_waitcnt lgkmcnt(0)
    s_add_u32 m0, s40, 2048
    s_nop 0
    global_load_lds_dwordx4 v8, s[66:67]
    s_add_u32 m0, s40, 3072
    s_nop 0
    global_load_lds_dwordx4 v9, s[66:67]
    s_add_u32 s66, s66, 0x4000
    s_addc_u32 s67, s67, 0
    s_waitcnt vmcnt(4)
    ds_read_b64_tr_b16 v[52:53], v3 offset:4096
    ds_read_b64_tr_b16 v[54:55], v3 offset:5120
    ds_read_b64_tr_b16 v[56:57], v10 offset:4096
    ds_read_b64_tr_b16 v[58:59], v10 offset:5120
    s_waitcnt lgkmcnt(0)
    s_add_u32 m0, s40, 4096
    s_nop 0
    global_load_lds_dwordx4 v8, s[66:67]
    s_add_u32 m0, s40, 5120
    s_nop 0
    global_load_lds_dwordx4 v9, s[66:67]
    s_add_u32 s66, s66, 0x4000
    s_addc_u32 s67, s67, 0
    s_waitcnt vmcnt(4)
    ds_read_b64_tr_b16 v[60:61], v3 offset:0
    ds_read_b64_tr_b16 v[62:63], v3 offset:1024
    ds_read_b64_tr_b16 v[64:65], v10 offset:0
    ds_read_b64_tr_b16 v[66:67], v10 offset:1024
    s_waitcnt lgkmcnt(0)
    s_add_u32 m0, s40, 0
    s_nop 0
    global_load_lds_dwordx4 v8, s[66:67]
    s_add_u32 m0, s40, 1024
    s_nop 0
    global_load_lds_dwordx4 v9, s[66:67]
    s_add_u32 s66, s66, 0x4000
    s_addc_u32 s67, s67, 0
    s_waitcnt vmcnt(4)
    ds_read_b64_tr_b16 v[68:69], v3 offset:2048
    ds_read_b64_tr_b16 v[70:71], v3 offset:3072
    ds_read_b64_tr_b16 v[72:73], v10 offset:2048
    ds_read_b64_tr_b16 v[74:75], v10 offset:3072
    s_waitcnt lgkmcnt(0)
    s_add_u32 m0, s40, 2048
    s_nop 0
    global_load_lds_dwordx4 v8, s[66:67]
    s_add_u32 m0, s40, 3072
    s_nop 0
    global_load_lds_dwordx4 v9, s[66:67]
    s_add_u32 s66, s66, 0x4000
    s_addc_u32 s67, s67, 0
    s_waitcnt vmcnt(4)
    ds_read_b64_tr_b16 v[76:77], v3 offset:4096
    ds_read_b64_tr_b16 v[78:79], v3 offset:5120
    ds_read_b64_tr_b16 v[80:81], v10 offset:4096
    ds_read_b64_tr_b16 v[82:83], v10 offset:5120
    s_waitcnt vmcnt(2)
    ds_read_b64_tr_b16 v[84:85], v3 offset:0
    ds_read_b64_tr_b16 v[86:87], v3 offset:1024
    ds_read_b64_tr_b16 v[88:89], v10 offset:0
    ds_read_b64_tr_b16 v[90:91], v10 offset:1024
    s_waitcnt vmcnt(0)
    ds_read_b64_tr_b16 v[92:93], v3 offset:2048
    ds_read_b64_tr_b16 v[94:95], v3 offset:3072
    ds_read_b64_tr_b16 v[96:97], v10 offset:2048
    ds_read_b64_tr_b16 v[98:99], v10 offset:3072
    s_waitcnt lgkmcnt(0)
    s_cmp_lg_u32 s31, 0
    s_cbranch_scc1 L_g6
    v_mov_b32 v13, s58
    s_mov_b64 exec, 1
    v_mov_b32 v12, 0
    v_mov_b32 v14, 1
    global_atomic_add v15, v12, v14, s[24:25] sc0 sc1
    s_waitcnt vmcnt(0)
    v_cmp_eq_u32 vcc, 0xff, v15
    s_cbranch_vccz L_g6a
    v_mov_b32 v12, 208896
    global_store_dword v12, v13, s[26:27] sc1
L_g6a:
    s_mov_b64 exec, -1
L_g6:
    v_and_b32 v12, 7, v1
    v_lshlrev_b32 v12, 2, v12
    s_mov_b32 s60, 65536
L_hpoll:
    global_load_dword v13, v12, s[36:37] sc1
    s_waitcnt vmcnt(0)
    v_cmp_ne_u32 vcc, s58, v13
    s_cbranch_vccz L_hpoll_ok
    s_sleep 8
    s_sub_u32 s60, s60, 1
    s_cmp_lg_u32 s60, 0
    s_cbranch_scc1 L_hpoll
L_hpoll_ok:
    s_mul_i32 s50, s31, 22
    s_cmp_eq_u32 s31, 3
    s_cselect_b32 s50, 65, s50
    s_cmp_ge_u32 s31, 2
    s_cselect_b32 s61, 21, 22
    s_sub_u32 s41, s61, 1
    s_lshl_b32 s52, s50, 14
    s_lshl_b32 s54, s29, 7
    s_add_u32 s52, s52, s54
    s_add_u32 s66, s18, s52
    s_addc_u32 s67, s19, 0
    s_lshl_b32 s50, s50, 11
    s_add_u32 s68, s46, s50
    s_addc_u32 s69, s47, 0
    s_add_u32 m0, s40, 0
    s_nop 0
    global_load_lds_dwordx4 v8, s[66:67]
    s_add_u32 m0, s40, 1024
    s_nop 0
    global_load_lds_dwordx4 v9, s[66:67]
    global_load_dwordx4 v[12:15], v11, s[68:69] sc1
    global_load_dwordx4 v[16:19], v0, s[68:69] sc1
    s_cmp_lg_u32 s41, 0
    s_cselect_b32 s50, 16384, 0
    s_cselect_b32 s52, 2048, 0
    s_cselect_b32 s54, 1, 0
    s_sub_u32 s41, s41, s54
    s_add_u32 s66, s66, s50
    s_addc_u32 s67, s67, 0
    s_add_u32 s68, s68, s52
    s_addc_u32 s69, s69, 0
    s_add_u32 m0, s40, 2048
    s_nop 0
    global_load_lds_dwordx4 v8, s[66:67]
    s_add_u32 m0, s40, 3072
    s_nop 0
    global_load_lds_dwordx4 v9, s[66:67]
    global_load_dwordx4 v[20:23], v11, s[68:69] sc1
    global_load_dwordx4 v[24:27], v0, s[68:69] sc1
    s_cmp_lg_u32 s41, 0
    s_cselect_b32 s50, 16384, 0
    s_cselect_b32 s52, 2048, 0
    s_cselect_b32 s54, 1, 0
    s_sub_u32 s41, s41, s54
    s_add_u32 s66, s66, s50
    s_addc_u32 s67, s67, 0
    s_add_u32 s68, s68, s52
    s_addc_u32 s69, s69, 0
    s_add_u32 m0, s40, 4096
    s_nop 0
    global_load_lds_dwordx4 v8, s[66:67]
    s_add_u32 m0, s40, 5120
    s_nop 0
    global_load_lds_dwordx4 v9, s[66:67]
    global_load_dwordx4 v[28:31], v11, s[68:69] sc1
    global_load_dwordx4 v[32:35], v0, s[68:69] sc1
    s_cmp_lg_u32 s41, 0
    s_cselect_b32 s50, 16384, 0
    s_cselect_b32 s52, 2048, 0
    s_cselect_b32 s54, 1, 0
    s_sub_u32 s41, s41, s54
    s_add_u32 s66, s66, s50
    s_addc_u32 s67, s67, 0
    s_add_u32 s68, s68, s52
    s_addc_u32 s69, s69, 0
    s_waitcnt vmcnt(8)
    ds_read_b64_tr_b16 v[4:5], v3 offset:0
    ds_read_b64_tr_b16 v[6:7], v3 offset:1024
    s_waitcnt lgkmcnt(0)
    v_mfma_f32_32x32x16_bf16 v[100:115], v[4:7], v[12:15], 0
    ds_read_b64_tr_b16 v[164:165], v10 offset:0
    ds_read_b64_tr_b16 v[166:167], v10 offset:1024
    s_waitcnt lgkmcnt(0)
    v_mfma_f32_32x32x16_bf16 v[116:131], v[4:7], v[16:19], 0
    s_add_u32 m0, s40, 0
    s_nop 0
    global_load_lds_dwordx4 v8, s[66:67]
    v_mfma_f32_32x32x16_bf16 v[132:147], v[164:167], v[12:15], 0
    s_add_u32 m0, s40, 1024
    s_nop 0
    global_load_lds_dwordx4 v9, s[66:67]
    v_mfma_f32_32x32x16_bf16 v[148:163], v[164:167], v[16:19], 0
    global_load_dwordx4 v[12:15], v11, s[68:69] sc1
    global_load_dwordx4 v[16:19], v0, s[68:69] sc1
    s_cmp_lg_u32 s41, 0
    s_cselect_b32 s50, 16384, 0
    s_cselect_b32 s52, 2048, 0
    s_cselect_b32 s54, 1, 0
    s_sub_u32 s41, s41, s54
    s_add_u32 s66, s66, s50
    s_addc_u32 s67, s67, 0
    s_add_u32 s68, s68, s52
    s_addc_u32 s69, s69, 0
    s_sub_u32 s61, s61, 1
L_g2loop:
    s_waitcnt vmcnt(8)
    ds_read_b64_tr_b16 v[4:5], v3 offset:2048
    ds_read_b64_tr_b16 v[6:7], v3 offset:3072
    s_waitcnt lgkmcnt(0)
    v_mfma_f32_32x32x16_bf16 v[100:115], v[4:7], v[20:23], v[100:115]
    ds_read_b64_tr_b16 v[164:165], v10 offset:2048
    ds_read_b64_tr_b16 v[166:167], v10 offset:3072
    s_waitcnt lgkmcnt(0)
    v_mfma_f32_32x32x16_bf16 v[116:131], v[4:7], v[24:27], v[116:131]
    s_add_u32 m0, s40, 2048
    s_nop 0
    global_load_lds_dwordx4 v8, s[66:67]
    v_mfma_f32_32x32x16_bf16 v[132:147], v[164:167], v[20:23], v[132:147]
    s_add_u32 m0, s40, 3072
    s_nop 0
    global_load_lds_dwordx4 v9, s[66:67]
    v_mfma_f32_32x32x16_bf16 v[148:163], v[164:167], v[24:27], v[148:163]
    global_load_dwordx4 v[20:23], v11, s[68:69] sc1
    global_load_dwordx4 v[24:27], v0, s[68:69] sc1
    s_cmp_lg_u32 s41, 0
    s_cselect_b32 s50, 16384, 0
    s_cselect_b32 s52, 2048, 0
    s_cselect_b32 s54, 1, 0
    s_sub_u32 s41, s41, s54
    s_add_u32 s66, s66, s50
    s_addc_u32 s67, s67, 0
    s_add_u32 s68, s68, s52
    s_addc_u32 s69, s69, 0
    s_sub_u32 s61, s61, 1
    s_cmp_eq_u32 s61, 0
    s_cbranch_scc1 L_g2done
    s_waitcnt vmcnt(8)
    ds_read_b64_tr_b16 v[4:5], v3 offset:4096
    ds_read_b64_tr_b16 v[6:7], v3 offset:5120
    s_waitcnt lgkmcnt(0)
    v_mfma_f32_32x32x16_bf16 v[100:115], v[4:7], v[28:31], v[100:115]
    ds_read_b64_tr_b16 v[164:165], v10 offset:4096
    ds_read_b64_tr_b16 v[166:167], v10 offset:5120
    s_waitcnt lgkmcnt(0)
    v_mfma_f32_32x32x16_bf16 v[116:131], v[4:7], v[32:35], v[116:131]
    s_add_u32 m0, s40, 4096
    s_nop 0
    global_load_lds_dwordx4 v8, s[66:67]
    v_mfma_f32_32x32x16_bf16 v[132:147], v[164:167], v[28:31], v[132:147]
    s_add_u32 m0, s40, 5120
    s_nop 0
    global_load_lds_dwordx4 v9, s[66:67]
    v_mfma_f32_32x32x16_bf16 v[148:163], v[164:167], v[32:35], v[148:163]
    global_load_dwordx4 v[28:31], v11, s[68:69] sc1
    global_load_dwordx4 v[32:35], v0, s[68:69] sc1
    s_cmp_lg_u32 s41, 0
    s_cselect_b32 s50, 16384, 0
    s_cselect_b32 s52, 2048, 0
    s_cselect_b32 s54, 1, 0
    s_sub_u32 s41, s41, s54
    s_add_u32 s66, s66, s50
    s_addc_u32 s67, s67, 0
    s_add_u32 s68, s68, s52
    s_addc_u32 s69, s69, 0
    s_sub_u32 s61, s61, 1
    s_cmp_eq_u32 s61, 0
    s_cbranch_scc1 L_g2done
    s_waitcnt vmcnt(8)
    ds_read_b64_tr_b16 v[4:5], v3 offset:0
    ds_read_b64_tr_b16 v[6:7], v3 offset:1024
    s_waitcnt lgkmcnt(0)
    v_mfma_f32_32x32x16_bf16 v[100:115], v[4:7], v[12:15], v[100:115]
    ds_read_b64_tr_b16 v[164:165], v10 offset:0
    ds_read_b64_tr_b16 v[166:167], v10 offset:1024
    s_waitcnt lgkmcnt(0)
    v_mfma_f32_32x32x16_bf16 v[116:131], v[4:7], v[16:19], v[116:131]
    s_add_u32 m0, s40, 0
    s_nop 0
    global_load_lds_dwordx4 v8, s[66:67]
    v_mfma_f32_32x32x16_bf16 v[132:147], v[164:167], v[12:15], v[132:147]
    s_add_u32 m0, s40, 1024
    s_nop 0
    global_load_lds_dwordx4 v9, s[66:67]
    v_mfma_f32_32x32x16_bf16 v[148:163], v[164:167], v[16:19], v[148:163]
    global_load_dwordx4 v[12:15], v11, s[68:69] sc1
    global_load_dwordx4 v[16:19], v0, s[68:69] sc1
    s_cmp_lg_u32 s41, 0
    s_cselect_b32 s50, 16384, 0
    s_cselect_b32 s52, 2048, 0
    s_cselect_b32 s54, 1, 0
    s_sub_u32 s41, s41, s54
    s_add_u32 s66, s66, s50
    s_addc_u32 s67, s67, 0
    s_add_u32 s68, s68, s52
    s_addc_u32 s69, s69, 0
    s_sub_u32 s61, s61, 1
    s_cmp_eq_u32 s61, 0
    s_cbranch_scc0 L_g2loop
L_g2done:
    s_and_b32 s50, s31, 1
    s_lshl_b32 s50, s50, 7
    s_add_u32 s50, s50, 161792
    v_and_b32 v4, 31, v1
    v_lshl_add_u32 v4, v4, 2, s50
    v_xor_b32 v5, 0x80, v4
    ds_read_b32 v6, v4
    ds_read_b32 v8, v5
    s_waitcnt vmcnt(0) lgkmcnt(0)
    v_sub_f32 v6, 1.0, v6
    v_sub_f32 v8, 1.0, v8
    s_nop 3
    v_pk_mul_f32 v[100:101], v[100:101], v[6:7] op_sel_hi:[1,0]
    v_pk_mul_f32 v[102:103], v[102:103], v[6:7] op_sel_hi:[1,0]
    v_pk_mul_f32 v[104:105], v[104:105], v[6:7] op_sel_hi:[1,0]
    v_pk_mul_f32 v[106:107], v[106:107], v[6:7] op_sel_hi:[1,0]
    v_pk_mul_f32 v[108:109], v[108:109], v[6:7] op_sel_hi:[1,0]
    v_pk_mul_f32 v[110:111], v[110:111], v[6:7] op_sel_hi:[1,0]
    v_pk_mul_f32 v[112:113], v[112:113], v[6:7] op_sel_hi:[1,0]
    v_pk_mul_f32 v[114:115], v[114:115], v[6:7] op_sel_hi:[1,0]
    v_pk_mul_f32 v[116:117], v[116:117], v[8:9] op_sel_hi:[1,0]
    v_pk_mul_f32 v[118:119], v[118:119], v[8:9] op_sel_hi:[1,0]
    v_pk_mul_f32 v[120:121], v[120:121], v[8:9] op_sel_hi:[1,0]
    v_pk_mul_f32 v[122:123], v[122:123], v[8:9] op_sel_hi:[1,0]
    v_pk_mul_f32 v[124:125], v[124:125], v[8:9] op_sel_hi:[1,0]
    v_pk_mul_f32 v[126:127], v[126:127], v[8:9] op_sel_hi:[1,0]
    v_pk_mul_f32 v[128:129], v[128:129], v[8:9] op_sel_hi:[1,0]
    v_pk_mul_f32 v[130:131], v[130:131], v[8:9] op_sel_hi:[1,0]
    v_pk_mul_f32 v[132:133], v[132:133], v[6:7] op_sel_hi:[1,0]
    v_pk_mul_f32 v[134:135], v[134:135], v[6:7] op_sel_hi:[1,0]
    v_pk_mul_f32 v[136:137], v[136:137], v[6:7] op_sel_hi:[1,0]
    v_pk_mul_f32 v[138:139], v[138:139], v[6:7] op_sel_hi:[1,0]
    v_pk_mul_f32 v[140:141], v[140:141], v[6:7] op_sel_hi:[1,0]
    v_pk_mul_f32 v[142:143], v[142:143], v[6:7] op_sel_hi:[1,0]
    v_pk_mul_f32 v[144:145], v[144:145], v[6:7] op_sel_hi:[1,0]
    v_pk_mul_f32 v[146:147], v[146:147], v[6:7] op_sel_hi:[1,0]
    v_pk_mul_f32 v[148:149], v[148:149], v[8:9] op_sel_hi:[1,0]
    v_pk_mul_f32 v[150:151], v[150:151], v[8:9] op_sel_hi:[1,0]
    v_pk_mul_f32 v[152:153], v[152:153], v[8:9] op_sel_hi:[1,0]
    v_pk_mul_f32 v[154:155], v[154:155], v[8:9] op_sel_hi:[1,0]
    v_pk_mul_f32 v[156:157], v[156:157], v[8:9] op_sel_hi:[1,0]
    v_pk_mul_f32 v[158:159], v[158:159], v[8:9] op_sel_hi:[1,0]
    v_pk_mul_f32 v[160:161], v[160:161], v[8:9] op_sel_hi:[1,0]
    v_pk_mul_f32 v[162:163], v[162:163], v[8:9] op_sel_hi:[1,0]
    v_mov_b32 v165, v11
    v_bfe_u32 v3, v1, 2, 1
    v_mul_u32_u24 v3, 8704, v3
    v_and_b32 v12, 3, v1
    v_mul_u32_u24 v12, 1088, v12
    v_lshrrev_b32 v13, 3, v1
    v_lshl_add_u32 v12, v13, 4, v12
    s_lshr_b32 s50, s31, 1
    s_mul_i32 s50, s50, 4352
    s_and_b32 s52, s31, 1
    s_lshl_b32 s52, s52, 8
    s_add_u32 s50, s50, s52
    v_add3_u32 v3, v3, v12, s50
    v_and_b32 v12, 7, v1
    v_lshlrev_b32 v166, 10, v13
    v_lshl_add_u32 v166, v12, 4, v166
    s_lshl2_add_u32 s50, s28, s31
    s_lshl_b32 s50, s50, 14
    s_lshl_b32 s52, s29, 7
    s_add_u32 s50, s50, s52
    s_add_u32 s34, s22, s50
    s_addc_u32 s35, s23, 0
    s_add_u32 s36, s34, 0x2000
    s_addc_u32 s37, s35, 0
    s_add_u32 s68, s48, 0x2000
    s_addc_u32 s69, s49, 0
    s_mul_i32 s50, s31, 17408
    s_xor_b32 s61, s31, 0
    s_mul_i32 s61, s61, 4352
    s_add_u32 s61, s61, s50
    s_xor_b32 s56, s31, 1
    s_mul_i32 s56, s56, 4352
    s_add_u32 s56, s56, s50
    s_xor_b32 s57, s31, 2
    s_mul_i32 s57, s57, 4352
    s_add_u32 s57, s57, s50
    s_xor_b32 s41, s31, 3
    s_mul_i32 s41, s41, 4352
    s_add_u32 s41, s41, s50
    s_setprio 0
    v_mov_b32 v164, 162076
    s_mov_b32 s60, 4194304
L_od0:
    ds_read_b32 v167, v164
    s_waitcnt lgkmcnt(0)
    v_readfirstlane_b32 s50, v167
    s_sub_u32 s60, s60, 1
    s_cmp_eq_u32 s60, 0
    s_cbranch_scc1 L_od0_ok
    s_cmp_ge_u32 s50, 4
    s_cbranch_scc1 L_od0_ok
    s_sleep 4
    s_branch L_od0
L_od0_ok:
    s_mov_b32 s60, 65536
L_opoll0:
    global_load_dwordx4 v[4:7], v165, s[48:49] offset:0 sc1
    global_load_dwordx4 v[8:11], v0, s[48:49] offset:0 sc1
    global_load_dwordx4 v[12:15], v165, s[48:49] offset:2048 sc1
    global_load_dwordx4 v[16:19], v0, s[48:49] offset:2048 sc1
    global_load_dwordx4 v[20:23], v165, s[68:69] offset:0 sc1
    global_load_dwordx4 v[24:27], v0, s[68:69] offset:0 sc1
    global_load_dwordx4 v[28:31], v165, s[68:69] offset:2048 sc1
    global_load_dwordx4 v[32:35], v0, s[68:69] offset:2048 sc1
    s_waitcnt vmcnt(4)
    v_max_u32 v164, v4, v5
    v_max3_u32 v164, v164, v6, v7
    v_max3_u32 v164, v164, v8, v9
    v_max3_u32 v164, v164, v10, v11
    v_max3_u32 v164, v164, v12, v13
    v_max3_u32 v164, v164, v14, v15
    v_max3_u32 v164, v164, v16, v17
    v_max3_u32 v164, v164, v18, v19
    s_waitcnt vmcnt(0)
    v_max3_u32 v164, v164, v20, v21
    v_max3_u32 v164, v164, v22, v23
    v_max3_u32 v164, v164, v24, v25
    v_max3_u32 v164, v164, v26, v27
    v_max3_u32 v164, v164, v28, v29
    v_max3_u32 v164, v164, v30, v31
    v_max3_u32 v164, v164, v32, v33
    v_max3_u32 v164, v164, v34, v35
    v_cmp_eq_u32 vcc, -1, v164
    s_cbranch_vccz L_ook0
    s_sleep 4
    s_sub_u32 s60, s60, 1
    s_cmp_lg_u32 s60, 0
    s_cbranch_scc1 L_opoll0
L_ook0:
    v_mfma_f32_32x32x16_bf16 v[100:115], v[36:39], v[4:7], v[100:115]
    v_mfma_f32_32x32x16_bf16 v[100:115], v[44:47], v[12:15], v[100:115]
    v_mfma_f32_32x32x16_bf16 v[100:115], v[68:71], v[20:23], v[100:115]
    v_mfma_f32_32x32x16_bf16 v[100:115], v[76:79], v[28:31], v[100:115]
    v_mfma_f32_32x32x16_bf16 v[116:131], v[36:39], v[8:11], v[116:131]
    v_mfma_f32_32x32x16_bf16 v[116:131], v[44:47], v[16:19], v[116:131]
    v_mfma_f32_32x32x16_bf16 v[116:131], v[68:71], v[24:27], v[116:131]
    v_mfma_f32_32x32x16_bf16 v[116:131], v[76:79], v[32:35], v[116:131]
    v_mfma_f32_32x32x16_bf16 v[132:147], v[40:43], v[4:7], v[132:147]
    v_mfma_f32_32x32x16_bf16 v[132:147], v[48:51], v[12:15], v[132:147]
    v_mfma_f32_32x32x16_bf16 v[132:147], v[72:75], v[20:23], v[132:147]
    v_mfma_f32_32x32x16_bf16 v[132:147], v[80:83], v[28:31], v[132:147]
    v_mfma_f32_32x32x16_bf16 v[148:163], v[40:43], v[8:11], v[148:163]
    v_mfma_f32_32x32x16_bf16 v[148:163], v[48:51], v[16:19], v[148:163]
    v_mfma_f32_32x32x16_bf16 v[148:163], v[72:75], v[24:27], v[148:163]
    v_mfma_f32_32x32x16_bf16 v[148:163], v[80:83], v[32:35], v[148:163]
    s_add_u32 s48, s48, 0x1000
    s_addc_u32 s49, s49, 0
    s_add_u32 s68, s68, 0x1000
    s_addc_u32 s69, s69, 0
    s_setprio 3
    v_mov_b32 v164, 162076
    s_mov_b32 s60, 4194304
L_od1:
    ds_read_b32 v167, v164
    s_waitcnt lgkmcnt(0)
    v_readfirstlane_b32 s50, v167
    s_sub_u32 s60, s60, 1
    s_cmp_eq_u32 s60, 0
    s_cbranch_scc1 L_od1_ok
    s_cmp_ge_u32 s50, 8
    s_cbranch_scc1 L_od1_ok
    s_sleep 1
    s_branch L_od1
L_od1_ok:
    s_mov_b32 s60, 65536
L_opoll1:
    global_load_dwordx4 v[4:7], v165, s[48:49] offset:0 sc1
    global_load_dwordx4 v[8:11], v0, s[48:49] offset:0 sc1
    global_load_dwordx4 v[12:15], v165, s[48:49] offset:2048 sc1
    global_load_dwordx4 v[16:19], v0, s[48:49] offset:2048 sc1
    global_load_dwordx4 v[20:23], v165, s[68:69] offset:0 sc1
    global_load_dwordx4 v[24:27], v0, s[68:69] offset:0 sc1
    global_load_dwordx4 v[28:31], v165, s[68:69] offset:2048 sc1
    global_load_dwordx4 v[32:35], v0, s[68:69] offset:2048 sc1
    s_waitcnt vmcnt(4)
    v_max_u32 v164, v4, v5
    v_max3_u32 v164, v164, v6, v7
    v_max3_u32 v164, v164, v8, v9
    v_max3_u32 v164, v164, v10, v11
    v_max3_u32 v164, v164, v12, v13
    v_max3_u32 v164, v164, v14, v15
    v_max3_u32 v164, v164, v16, v17
    v_max3_u32 v164, v164, v18, v19
    s_waitcnt vmcnt(0)
    v_max3_u32 v164, v164, v20, v21
    v_max3_u32 v164, v164, v22, v23
    v_max3_u32 v164, v164, v24, v25
    v_max3_u32 v164, v164, v26, v27
    v_max3_u32 v164, v164, v28, v29
    v_max3_u32 v164, v164, v30, v31
    v_max3_u32 v164, v164, v32, v33
    v_max3_u32 v164, v164, v34, v35
    v_cmp_eq_u32 vcc, -1, v164
    s_cbranch_vccz L_ook1
    s_sub_u32 s60, s60, 1
    s_cmp_lg_u32 s60, 0
    s_cbranch_scc1 L_opoll1
L_ook1:
    v_mfma_f32_32x32x16_bf16 v[148:163], v[56:59], v[8:11], v[148:163]
    v_mfma_f32_32x32x16_bf16 v[148:163], v[64:67], v[16:19], v[148:163]
    v_mfma_f32_32x32x16_bf16 v[148:163], v[88:91], v[24:27], v[148:163]
    v_mfma_f32_32x32x16_bf16 v[148:163], v[96:99], v[32:35], v[148:163]
    v_mfma_f32_32x32x16_bf16 v[132:147], v[56:59], v[4:7], v[132:147]
    v_mfma_f32_32x32x16_bf16 v[132:147], v[64:67], v[12:15], v[132:147]
    v_mfma_f32_32x32x16_bf16 v[132:147], v[88:91], v[20:23], v[132:147]
    v_mfma_f32_32x32x16_bf16 v[132:147], v[96:99], v[28:31], v[132:147]
    v_mfma_f32_32x32x16_bf16 v[116:131], v[52:55], v[8:11], v[116:131]
    v_mfma_f32_32x32x16_bf16 v[116:131], v[60:63], v[16:19], v[116:131]
    v_mfma_f32_32x32x16_bf16 v[116:131], v[84:87], v[24:27], v[116:131]
    v_mfma_f32_32x32x16_bf16 v[116:131], v[92:95], v[32:35], v[116:131]
    s_nop 2
    v_add_u32 v164, s41, v2
    ds_write_b128 v164, v[148:151] offset:0
    ds_write_b128 v164, v[152:155] offset:1088
    ds_write_b128 v164, v[156:159] offset:2176
    ds_write_b128 v164, v[160:163] offset:3264
    v_mfma_f32_32x32x16_bf16 v[100:115], v[52:55], v[4:7], v[100:115]
    v_mfma_f32_32x32x16_bf16 v[100:115], v[60:63], v[12:15], v[100:115]
    v_mfma_f32_32x32x16_bf16 v[100:115], v[84:87], v[20:23], v[100:115]
    v_mfma_f32_32x32x16_bf16 v[100:115], v[92:95], v[28:31], v[100:115]
L_ojoin:
    v_add_u32 v164, s57, v2
    ds_write_b128 v164, v[132:135] offset:0
    ds_write_b128 v164, v[136:139] offset:1088
    ds_write_b128 v164, v[140:143] offset:2176
    ds_write_b128 v164, v[144:147] offset:3264
    v_add_u32 v164, s56, v2
    ds_write_b128 v164, v[116:119] offset:0
    ds_write_b128 v164, v[120:123] offset:1088
    ds_write_b128 v164, v[124:127] offset:2176
    ds_write_b128 v164, v[128:131] offset:3264
    s_waitcnt lgkmcnt(8)
    v_add_u32 v164, s61, v2
    ds_write_b128 v164, v[100:103] offset:0
    ds_write_b128 v164, v[104:107] offset:1088
    ds_write_b128 v164, v[108:111] offset:2176
    ds_write_b128 v164, v[112:115] offset:3264
    s_waitcnt vmcnt(0)
    s_waitcnt lgkmcnt(0)
    s_barrier
    ds_read_b128 v[36:39], v3 offset:0
    ds_read_b128 v[40:43], v3 offset:512
    ds_read_b128 v[44:47], v3 offset:17408
    ds_read_b128 v[48:51], v3 offset:17920
    ds_read_b128 v[52:55], v3 offset:34816
    ds_read_b128 v[56:59], v3 offset:35328
    ds_read_b128 v[60:63], v3 offset:52224
    ds_read_b128 v[64:67], v3 offset:52736
    s_waitcnt lgkmcnt(4)
    ds_read_b128 v[68:71], v3 offset:128
    ds_read_b128 v[72:75], v3 offset:640
    ds_read_b128 v[76:79], v3 offset:17536
    ds_read_b128 v[80:83], v3 offset:18048
    ds_read_b128 v[84:87], v3 offset:34944
    ds_read_b128 v[88:91], v3 offset:35456
    ds_read_b128 v[92:95], v3 offset:52352
    ds_read_b128 v[96:99], v3 offset:52864
    s_waitcnt lgkmcnt(8)
    v_pk_add_f32 v[36:37], v[36:37], v[44:45]
    v_pk_add_f32 v[52:53], v[52:53], v[60:61]
    v_pk_add_f32 v[38:39], v[38:39], v[46:47]
    v_pk_add_f32 v[54:55], v[54:55], v[62:63]
    v_pk_add_f32 v[40:41], v[40:41], v[48:49]
    v_pk_add_f32 v[56:57], v[56:57], v[64:65]
    v_pk_add_f32 v[42:43], v[42:43], v[50:51]
    v_pk_add_f32 v[58:59], v[58:59], v[66:67]
    v_pk_add_f32 v[36:37], v[36:37], v[52:53]
    v_pk_add_f32 v[38:39], v[38:39], v[54:55]
    v_pk_add_f32 v[40:41], v[40:41], v[56:57]
    v_pk_add_f32 v[42:43], v[42:43], v[58:59]
    v_cvt_pk_bf16_f32 v16, v36, v37
    v_cvt_pk_bf16_f32 v17, v38, v39
    v_cvt_pk_bf16_f32 v18, v40, v41
    v_cvt_pk_bf16_f32 v19, v42, v43
    global_store_dwordx4 v166, v[16:19], s[34:35] sc1
    s_waitcnt lgkmcnt(0)
    v_pk_add_f32 v[68:69], v[68:69], v[76:77]
    v_pk_add_f32 v[84:85], v[84:85], v[92:93]
    v_pk_add_f32 v[70:71], v[70:71], v[78:79]
    v_pk_add_f32 v[86:87], v[86:87], v[94:95]
    v_pk_add_f32 v[72:73], v[72:73], v[80:81]
    v_pk_add_f32 v[88:89], v[88:89], v[96:97]
    v_pk_add_f32 v[74:75], v[74:75], v[82:83]
    v_pk_add_f32 v[90:91], v[90:91], v[98:99]
    v_pk_add_f32 v[68:69], v[68:69], v[84:85]
    v_pk_add_f32 v[70:71], v[70:71], v[86:87]
    v_pk_add_f32 v[72:73], v[72:73], v[88:89]
    v_pk_add_f32 v[74:75], v[74:75], v[90:91]
    v_cvt_pk_bf16_f32 v20, v68, v69
    v_cvt_pk_bf16_f32 v21, v70, v71
    v_cvt_pk_bf16_f32 v22, v72, v73
    v_cvt_pk_bf16_f32 v23, v74, v75
    global_store_dwordx4 v166, v[20:23], s[36:37] sc1
L_fin:
L_end:
    s_endpgm
L_code_end:
.section .rodata,"a"
.p2align 6
.amdhsa_kernel gated_mix__grouped_kv_mqa__dense_activation_silu__prompt_kernel
  .amdhsa_next_free_vgpr 168
  .amdhsa_next_free_sgpr 102
  .amdhsa_accum_offset 168
  .amdhsa_group_segment_fixed_size 0
  .amdhsa_kernarg_size 96
  .amdhsa_user_sgpr_count 2
  .amdhsa_user_sgpr_kernarg_segment_ptr 1
  .amdhsa_system_sgpr_workgroup_id_x 1
.end_amdhsa_kernel
```
